```python
import torch

def _softmax(x, axis=-1):
    return torch.softmax(x, dim=axis)
def _gelu(x):
    return torch.nn.functional.gelu(x, approximate="tanh")
def _silu(x):
    return torch.nn.functional.silu(x)
def _sigmoid(x):
    return torch.sigmoid(x)
def _layernorm(x, axis=-1, eps=1e-5):
    m = x.mean(dim=axis, keepdim=True)
    v = x.var(dim=axis, keepdim=True, unbiased=False)
    return (x - m) / torch.sqrt(v + eps)
def _scatter_add(tgt, idx, src, axis=0):
    return tgt.clone().index_add_(axis, idx, src)
def _segment_sum(src, seg, n):
    out = torch.zeros((n,) + src.shape[1:], dtype=src.dtype)
    return out.index_add_(0, seg, src)
def _pad(x, pw):
    flat = tuple(v for pair in reversed(pw) for v in pair)
    return torch.nn.functional.pad(x, flat)

kernel_name = 'concat_heads__sliding_local_dilated__sliding_local_dilated__prompt'

def setup_inputs():

    _w = (lambda a: (lambda t: t.to(torch.bfloat16) if t.is_floating_point() else t)(torch.as_tensor(a)))
    def _A_setup():
        B, S, D = 1, 2048, 512
        return {
            "x": _w((lambda *s: torch.randn(*s, dtype=torch.bfloat16) * 0.2)(B, S, D)),
            "wqkv": _w((lambda *s: torch.randn(*s, dtype=torch.bfloat16) * 0.2)(D, 3 * D)),
            "wo": _w((lambda *s: torch.randn(*s, dtype=torch.bfloat16) * 0.05)(D, D)),
        }
    _A_in = _A_setup()

    def _B_setup():
        B, S, D = 1, 2048, 512
        return {
            "x": _w((lambda *s: torch.randn(*s, dtype=torch.bfloat16) * 0.2)(B, S, D)),
            "wqkv": _w((lambda *s: torch.randn(*s, dtype=torch.bfloat16) * 0.2)(D, 3 * D)),
            "wo": _w((lambda *s: torch.randn(*s, dtype=torch.bfloat16) * 0.05)(D, D)),
        }
    _B_in = _B_setup()

    return {
        "A_x": _A_in["x"],
        "A_wqkv": _A_in["wqkv"],
        "A_wo": _A_in["wo"],
        "B_x": _B_in["x"],
        "B_wqkv": _B_in["wqkv"],
        "B_wo": _B_in["wo"],
    }

def reference(A_x, A_wqkv, A_wo, B_x, B_wqkv, B_wo):
    def _A_ref(x, wqkv, wo):
        B, S, D = x.shape
        H = 32; Dh = D // H
        W, dil = 8, 2
        qkv = (lambda x, *d: x.permute(*d))((x @ wqkv).reshape(B, S, 3, H, Dh), 2, 0, 3, 1, 4)
        q, k, v = qkv[0], qkv[1], qkv[2]
        scale = Dh ** -0.5
        pos = torch.arange(S)
        off = torch.arange(W) * dil
        idx = pos[:, None] - off[None, :]
        mask = idx >= 0
        idx_c = torch.where(mask, idx, 0).reshape(-1)
        kg = k[:, :, idx_c, :].reshape(B, H, S, W, Dh)
        vg = v[:, :, idx_c, :].reshape(B, H, S, W, Dh)
        logits = torch.einsum("bhsd,bhswd->bhsw", q, kg) * scale
        logits = torch.where(mask[None, None, :, :], logits, -1e9)
        attn = _softmax(logits, axis=-1)
        o = torch.einsum("bhsw,bhswd->bhsd", attn, vg)
        return (lambda x, *d: x.permute(*d))(o, 0, 2, 1, 3).reshape(B, S, D) @ wo

    def _B_ref(x, wqkv, wo):
        B, S, D = x.shape
        H = 32; Dh = D // H
        W, dil = 8, 2
        qkv = (lambda x, *d: x.permute(*d))((x @ wqkv).reshape(B, S, 3, H, Dh), 2, 0, 3, 1, 4)
        q, k, v = qkv[0], qkv[1], qkv[2]
        scale = Dh ** -0.5
        pos = torch.arange(S)
        off = torch.arange(W) * dil
        idx = pos[:, None] - off[None, :]
        mask = idx >= 0
        idx_c = torch.where(mask, idx, 0).reshape(-1)
        kg = k[:, :, idx_c, :].reshape(B, H, S, W, Dh)
        vg = v[:, :, idx_c, :].reshape(B, H, S, W, Dh)
        logits = torch.einsum("bhsd,bhswd->bhsw", q, kg) * scale
        logits = torch.where(mask[None, None, :, :], logits, -1e9)
        attn = _softmax(logits, axis=-1)
        o = torch.einsum("bhsw,bhswd->bhsd", attn, vg)
        return (lambda x, *d: x.permute(*d))(o, 0, 2, 1, 3).reshape(B, S, D) @ wo

    a = _A_ref(A_x, A_wqkv, A_wo)
    b = _B_ref(B_x, B_wqkv, B_wo)
    return torch.concatenate([a, b], axis=-1)
```

```asm
; @launch grid=(256,1,1) block=(512,1,1) lds=163840
.amdgcn_target "amdgcn-amd-amdhsa--gfx950"
.text
.globl concat_heads__sliding_local_dilated__sliding_local_dilated__prompt_kernel
.p2align 8
.type concat_heads__sliding_local_dilated__sliding_local_dilated__prompt_kernel,@function
concat_heads__sliding_local_dilated__sliding_local_dilated__prompt_kernel:
    s_cmp_ge_u32 s2, 256
    s_cbranch_scc1 L_end
    s_load_dwordx16 s[4:19], s[0:1], 0
    s_load_dwordx2 s[20:21], s[0:1], 64
    s_getpc_b64 s[22:23]
L_pc:
    s_bfe_u32 s57, s2, 0x20003
    s_mul_i32 s57, s57, L_w1-L_w0
    v_lshlrev_b32 v1, 6, v0
    v_min_u32 v1, L_w1-L_pc, v1
    v_mov_b32 v2, s57
    v_cmp_lt_u32 vcc, L_w0-L_pc, v1
    v_lshrrev_b32 v3, 6, v0
    s_and_b32 s55, s2, 7
    v_cndmask_b32 v2, 0, v2, vcc
    v_add_u32 v1, v1, v2
    global_load_dword v255, v1, s[22:23]
    s_lshr_b32 s56, s2, 3
    v_readfirstlane_b32 s48, v3
    v_and_b32 v0, 63, v0
    s_lshr_b32 s49, s56, 3
    s_lshl_b32 s55, s55, 2
    s_add_u32 s49, s49, s55
    s_and_b32 s50, s56, 7
    s_lshr_b32 s51, s49, 4
    s_bfe_u32 s52, s49, 0x10003
    s_and_b32 s53, s49, 7
    s_xor_b32 s48, s48, 4
    s_cmp_ge_u32 s48, 4
    s_cbranch_scc0 L_compute
    s_add_u32 s54, s49, s50
    s_and_b32 s54, s54, 1
    s_cmp_eq_u32 s54, 0
    s_mov_b32 s54, 1732584208
    s_cselect_b32 s54, s54, 1969438753
    s_and_b32 s94, s49, 12
    s_lshr_b32 s94, 16448, s94
    s_and_b32 s94, s94, 7
    s_mul_i32 s94, s94, 0x11111111
    s_xor_b32 s54, s54, s94
    s_lshr_b32 s94, s50, 1
    s_bfe_u32 s95, s49, 0x10001
    s_sub_u32 s55, s48, 4
    v_lshrrev_b32 v3, 3, v0
    v_and_b32 v4, 7, v0
    v_lshrrev_b32 v5, 4, v0
    v_xor_b32 v6, v4, v5
    v_lshlrev_b32 v6, 4, v6
    v_lshl_add_u32 v6, v3, 11, v6
    s_lshl_b32 s61, s53, 18
    s_lshl_b32 s62, s52, 10
    s_add_u32 s61, s61, s62
    s_sub_u32 s60, s61, 16384
    s_cmp_eq_u32 s53, 0
    s_cselect_b32 s60, 0x40000000, s60
    s_lshl_b32 s62, s55, 16
    s_add_u32 s61, s61, s62
    s_lshl_b32 s56, s55, 12
    s_add_u32 s58, s94, 0
    s_and_b32 s58, s58, 3
    s_lshl_b32 s88, s58, 10
    s_add_u32 s88, s88, s56
    s_and_b32 s62, s58, 1
    s_lshl_b32 s62, s62, 6
    s_lshl_b32 s58, s58, 14
    s_add_u32 s58, s58, s61
    v_xor_b32 v8, s62, v6
    v_add_u32 v8, s58, v8
    s_add_u32 s58, s94, 1
    s_and_b32 s58, s58, 3
    s_lshl_b32 s89, s58, 10
    s_add_u32 s89, s89, s56
    s_and_b32 s62, s58, 1
    s_lshl_b32 s62, s62, 6
    s_lshl_b32 s58, s58, 14
    s_add_u32 s58, s58, s61
    v_xor_b32 v9, s62, v6
    v_add_u32 v9, s58, v9
    s_add_u32 s58, s94, 2
    s_and_b32 s58, s58, 3
    s_lshl_b32 s90, s58, 10
    s_add_u32 s90, s90, s56
    s_and_b32 s62, s58, 1
    s_lshl_b32 s62, s62, 6
    s_lshl_b32 s58, s58, 14
    s_add_u32 s58, s58, s61
    v_xor_b32 v10, s62, v6
    v_add_u32 v10, s58, v10
    s_add_u32 s58, s94, 3
    s_and_b32 s58, s58, 3
    s_lshl_b32 s91, s58, 10
    s_add_u32 s91, s91, s56
    s_and_b32 s62, s58, 1
    s_lshl_b32 s62, s62, 6
    s_lshl_b32 s58, s58, 14
    s_add_u32 s58, s58, s61
    v_xor_b32 v11, s62, v6
    v_add_u32 v11, s58, v11
    v_lshlrev_b32 v7, 1, v5
    v_xor_b32 v6, v4, v7
    v_lshlrev_b32 v6, 4, v6
    v_lshl_add_u32 v6, v3, 11, v6
    v_add_u32 v14, s60, v6
    v_and_b32 v7, 2, v7
    v_xor_b32 v7, v7, v4
    v_lshlrev_b32 v7, 4, v7
    v_mul_u32_u24 v6, 3072, v3
    v_add_u32 v7, v7, v6
    s_mul_i32 s61, s55, 49152
    s_lshl_b32 s62, s50, 7
    s_add_u32 s61, s61, s62
    s_mul_i32 s57, s55, 6144
    s_xor_b32 s58, s95, 0
    s_mul_i32 s92, s58, 3072
    s_add_u32 s92, s92, s57
    s_lshl_b32 s62, s58, 6
    s_mul_i32 s58, s58, 24576
    s_add_u32 s58, s58, s61
    v_xor_b32 v12, s62, v7
    v_add_u32 v12, s58, v12
    s_xor_b32 s58, s95, 1
    s_mul_i32 s93, s58, 3072
    s_add_u32 s93, s93, s57
    s_lshl_b32 s62, s58, 6
    s_mul_i32 s58, s58, 24576
    s_add_u32 s58, s58, s61
    v_xor_b32 v13, s62, v7
    v_add_u32 v13, s58, v13
    s_lshl_b32 s61, s55, 4
    s_lshl_b64 s[100:101], 0xffff, s61
    s_waitcnt lgkmcnt(0)
    s_cmp_eq_u32 s51, 0
    s_cselect_b32 s24, s4, s10
    s_cselect_b32 s25, s5, s11
    s_mov_b32 s26, 0x200000
    s_mov_b32 s27, 0x20000
    s_cselect_b32 s28, s6, s12
    s_cselect_b32 s29, s7, s13
    s_mov_b32 s30, 0x180000
    s_mov_b32 s31, 0x20000
    s_cselect_b32 s32, s8, s14
    s_cselect_b32 s33, s9, s15
    s_mov_b32 s34, 0x80000
    s_bfe_u32 s61, s54, 196608
    s_add_u32 m0, s92, 24576
    s_mul_i32 s59, s61, 196608
    s_lshl_b32 s58, s61, 7
    buffer_load_dwordx4 v12, s[28:31], s59 offen offset:0  lds
    buffer_load_dwordx4 v12, s[28:31], s59 offen offset:1024  lds
    buffer_load_dwordx4 v12, s[28:31], s59 offen offset:2048  lds
    s_add_u32 m0, s88, 8192
    s_nop 0
    buffer_load_dwordx4 v8, s[24:27], s58 offen  lds
    s_mov_b32 m0, 0
    s_mov_b64 exec, s[100:101]
    buffer_load_dwordx4 v14, s[24:27], s58 offen  lds
    s_add_u32 m0, s93, 24576
    s_mov_b64 exec, -1
    buffer_load_dwordx4 v13, s[28:31], s59 offen offset:0  lds
    buffer_load_dwordx4 v13, s[28:31], s59 offen offset:1024  lds
    buffer_load_dwordx4 v13, s[28:31], s59 offen offset:2048  lds
    s_add_u32 m0, s89, 8192
    s_nop 0
    buffer_load_dwordx4 v9, s[24:27], s58 offen  lds
    s_add_u32 m0, s90, 8192
    s_nop 0
    buffer_load_dwordx4 v10, s[24:27], s58 offen  lds
    s_add_u32 m0, s91, 8192
    s_nop 0
    buffer_load_dwordx4 v11, s[24:27], s58 offen  lds
    s_mov_b32 s35, 0x20000
    s_mov_b32 s40, s20
    s_mov_b32 s41, s21
    s_mov_b32 s42, 0x10000000
    s_mov_b32 s43, 0x20000
    s_mov_b32 s36, s16
    s_mov_b32 s37, s17
    s_mov_b32 s38, 0x400000
    s_mov_b32 s39, 0x20000
    v_lshlrev_b32 v250, 6, v0
    v_and_b32 v1, 15, v0
    v_lshlrev_b32 v1, 6, v1
    v_lshrrev_b32 v2, 4, v0
    v_lshl_add_u32 v252, v2, 15, v1
    s_cmp_eq_u32 s54, 1732584208
    s_cselect_b32 s22, 0, 0x40000000
    s_cselect_b32 s23, 0x40000000, 0
    s_and_b32 s16, s49, 3
    s_lshl_b32 s16, s16, 3
    s_add_u32 s16, s16, s50
    s_lshl_b32 s16, s16, 2
    s_add_u32 s16, s16, s55
    s_lshl_b32 s16, s16, 12
    s_lshl_b32 s17, s49, 5
    s_add_u32 s17, s17, s50
    s_lshl_b32 s17, s17, 2
    s_add_u32 s17, s17, s55
    s_lshl_b32 s17, s17, 10
    s_lshl_b32 s19, s49, 7
    s_add_u32 s61, s19, 8454144
    s_load_dword s44, s[20:21], s61
    v_and_b32 v1, 1, v0
    v_bfe_u32 v2, v0, 1, 1
    v_lshl_add_u32 v1, v1, 1, v2
    v_bfe_u32 v2, v0, 4, 1
    v_lshl_add_u32 v1, v2, 2, v1
    v_lshlrev_b32 v1, 3, v1
    v_bfe_u32 v2, v0, 3, 1
    v_lshl_add_u32 v1, v2, 6, v1
    v_bfe_u32 v2, v0, 2, 2
    v_lshl_add_u32 v1, v2, 7, v1
    v_lshrrev_b32 v2, 5, v0
    v_lshl_add_u32 v1, v2, 10, v1
    s_lshl_b32 s46, s49, 2
    s_mov_b32 s3, s55
    s_add_u32 s46, s46, s3
    s_lshl_b32 s45, s46, 7
    s_add_u32 s45, s45, 8388608
    s_lshl_b32 s46, s46, 15
    s_sub_u32 s61, s3, 0
    s_and_b32 s61, s61, 3
    s_lshl_b32 s62, s61, 12
    s_add_u32 s12, s62, s46
    s_lshl_b32 s61, s61, 13
    s_add_u32 s61, s61, 98304
    v_add_u32 v224, s61, v1
    v_xor_b32 v225, 64, v224
    s_sub_u32 s61, s3, 1
    s_and_b32 s61, s61, 3
    s_lshl_b32 s62, s61, 12
    s_add_u32 s13, s62, s46
    s_lshl_b32 s61, s61, 13
    s_add_u32 s61, s61, 98304
    v_add_u32 v226, s61, v1
    v_xor_b32 v227, 64, v226
    s_sub_u32 s61, s3, 2
    s_and_b32 s61, s61, 3
    s_lshl_b32 s62, s61, 12
    s_add_u32 s14, s62, s46
    s_lshl_b32 s61, s61, 13
    s_add_u32 s61, s61, 98304
    v_add_u32 v228, s61, v1
    v_xor_b32 v229, 64, v228
    s_sub_u32 s61, s3, 3
    s_and_b32 s61, s61, 3
    s_lshl_b32 s62, s61, 12
    s_add_u32 s15, s62, s46
    s_lshl_b32 s61, s61, 13
    s_add_u32 s61, s61, 98304
    v_add_u32 v230, s61, v1
    v_xor_b32 v231, 64, v230
    v_lshlrev_b32 v232, 4, v0
    v_add_u32 v233, 16384, v232
    v_and_b32 v1, 7, v0
    v_lshlrev_b32 v234, 2, v1
    v_lshrrev_b32 v2, 5, v0
    v_xor_b32 v1, v1, v2
    v_lshlrev_b32 v1, 4, v1
    v_and_b32 v2, 31, v0
    v_lshl_add_u32 v1, v2, 7, v1
    s_lshl_b32 s61, s55, 12
    s_add_u32 s61, s61, 8192
    v_add_u32 v236, s61, v1
    v_xor_b32 v237, 32, v236
    v_xor_b32 v238, 64, v236
    v_xor_b32 v239, 96, v236
    v_add_u32 v240, s61, v232
    v_lshrrev_b32 v2, 3, v0
    v_and_b32 v1, 7, v0
    v_xor_b32 v1, v1, v2
    v_lshlrev_b32 v1, 4, v1
    v_lshl_add_u32 v241, v2, 12, v1
    s_lshl_b32 s46, s53, 19
    s_lshl_b32 s61, s55, 17
    s_add_u32 s46, s46, s61
    s_lshl_b32 s61, s52, 11
    s_add_u32 s46, s46, s61
    s_lshl_b32 s61, s51, 10
    s_add_u32 s46, s46, s61
    s_lshl_b32 s61, s50, 7
    s_add_u32 s46, s46, s61
    v_lshrrev_b32 v3, 3, v0
    v_and_b32 v4, 7, v0
    v_lshrrev_b32 v5, 2, v0
    v_and_b32 v5, 4, v5
    v_xor_b32 v4, v4, v5
    v_lshlrev_b32 v4, 4, v4
    v_lshl_add_u32 v4, v3, 10, v4
    s_lshl_b32 s61, s55, 17
    s_lshl_b32 s62, s50, 7
    s_add_u32 s61, s61, s62
    v_add_u32 v246, s61, v4
    v_add_u32 v247, 7168, v246
    v_add_u32 v248, 14336, v246
    v_add_u32 v249, 21504, v246
    s_bfe_u32 s61, s54, 196612
    s_add_u32 m0, s92, 65536
    s_mul_i32 s59, s61, 196608
    s_lshl_b32 s58, s61, 7
    buffer_load_dwordx4 v12, s[28:31], s59 offen offset:0  lds
    buffer_load_dwordx4 v12, s[28:31], s59 offen offset:1024  lds
    buffer_load_dwordx4 v12, s[28:31], s59 offen offset:2048  lds
    s_add_u32 m0, s88, 49152
    s_nop 0
    buffer_load_dwordx4 v8, s[24:27], s58 offen  lds
    s_mov_b32 m0, 1024
    s_mov_b64 exec, s[100:101]
    buffer_load_dwordx4 v14, s[24:27], s58 offen  lds
    s_add_u32 m0, s93, 65536
    s_mov_b64 exec, -1
    buffer_load_dwordx4 v13, s[28:31], s59 offen offset:0  lds
    buffer_load_dwordx4 v13, s[28:31], s59 offen offset:1024  lds
    buffer_load_dwordx4 v13, s[28:31], s59 offen offset:2048  lds
    s_add_u32 m0, s89, 49152
    s_nop 0
    buffer_load_dwordx4 v9, s[24:27], s58 offen  lds
    s_add_u32 m0, s90, 49152
    s_nop 0
    buffer_load_dwordx4 v10, s[24:27], s58 offen  lds
    s_add_u32 m0, s91, 49152
    s_nop 0
    buffer_load_dwordx4 v11, s[24:27], s58 offen  lds
    s_waitcnt vmcnt(11)
    s_barrier
    s_bfe_u32 s61, s54, 196616
    s_add_u32 m0, s92, 106496
    s_mul_i32 s59, s61, 196608
    s_lshl_b32 s58, s61, 7
    buffer_load_dwordx4 v12, s[28:31], s59 offen offset:0  lds
    buffer_load_dwordx4 v12, s[28:31], s59 offen offset:1024  lds
    buffer_load_dwordx4 v12, s[28:31], s59 offen offset:2048  lds
    s_add_u32 m0, s88, 90112
    s_nop 0
    buffer_load_dwordx4 v8, s[24:27], s58 offen  lds
    s_mov_b32 m0, 2048
    s_mov_b64 exec, s[100:101]
    buffer_load_dwordx4 v14, s[24:27], s58 offen  lds
    s_add_u32 m0, s93, 106496
    s_mov_b64 exec, -1
    buffer_load_dwordx4 v13, s[28:31], s59 offen offset:0  lds
    buffer_load_dwordx4 v13, s[28:31], s59 offen offset:1024  lds
    buffer_load_dwordx4 v13, s[28:31], s59 offen offset:2048  lds
    s_add_u32 m0, s89, 90112
    s_nop 0
    buffer_load_dwordx4 v9, s[24:27], s58 offen  lds
    s_add_u32 m0, s90, 90112
    s_nop 0
    buffer_load_dwordx4 v10, s[24:27], s58 offen  lds
    s_add_u32 m0, s91, 90112
    s_nop 0
    buffer_load_dwordx4 v11, s[24:27], s58 offen  lds
    s_waitcnt vmcnt(11)
    s_barrier
    s_bfe_u32 s61, s54, 196620
    s_add_u32 m0, s92, 24576
    s_mul_i32 s59, s61, 196608
    s_lshl_b32 s58, s61, 7
    buffer_load_dwordx4 v12, s[28:31], s59 offen offset:0  lds
    buffer_load_dwordx4 v12, s[28:31], s59 offen offset:1024  lds
    buffer_load_dwordx4 v12, s[28:31], s59 offen offset:2048  lds
    s_add_u32 m0, s88, 8192
    s_nop 0
    buffer_load_dwordx4 v8, s[24:27], s58 offen  lds
    s_mov_b32 m0, 3072
    s_mov_b64 exec, s[100:101]
    buffer_load_dwordx4 v14, s[24:27], s58 offen  lds
    s_add_u32 m0, s93, 24576
    s_mov_b64 exec, -1
    buffer_load_dwordx4 v13, s[28:31], s59 offen offset:0  lds
    buffer_load_dwordx4 v13, s[28:31], s59 offen offset:1024  lds
    buffer_load_dwordx4 v13, s[28:31], s59 offen offset:2048  lds
    s_add_u32 m0, s89, 8192
    s_nop 0
    buffer_load_dwordx4 v9, s[24:27], s58 offen  lds
    s_add_u32 m0, s90, 8192
    s_nop 0
    buffer_load_dwordx4 v10, s[24:27], s58 offen  lds
    s_add_u32 m0, s91, 8192
    s_nop 0
    buffer_load_dwordx4 v11, s[24:27], s58 offen  lds
    s_waitcnt vmcnt(11)
    s_barrier
    s_bfe_u32 s61, s54, 196624
    s_add_u32 m0, s92, 65536
    s_mul_i32 s59, s61, 196608
    s_lshl_b32 s58, s61, 7
    buffer_load_dwordx4 v12, s[28:31], s59 offen offset:0  lds
    buffer_load_dwordx4 v12, s[28:31], s59 offen offset:1024  lds
    buffer_load_dwordx4 v12, s[28:31], s59 offen offset:2048  lds
    s_add_u32 m0, s88, 49152
    s_nop 0
    buffer_load_dwordx4 v8, s[24:27], s58 offen  lds
    s_mov_b32 m0, 4096
    s_mov_b64 exec, s[100:101]
    buffer_load_dwordx4 v14, s[24:27], s58 offen  lds
    s_add_u32 m0, s93, 65536
    s_mov_b64 exec, -1
    buffer_load_dwordx4 v13, s[28:31], s59 offen offset:0  lds
    buffer_load_dwordx4 v13, s[28:31], s59 offen offset:1024  lds
    buffer_load_dwordx4 v13, s[28:31], s59 offen offset:2048  lds
    s_add_u32 m0, s89, 49152
    s_nop 0
    buffer_load_dwordx4 v9, s[24:27], s58 offen  lds
    s_add_u32 m0, s90, 49152
    s_nop 0
    buffer_load_dwordx4 v10, s[24:27], s58 offen  lds
    s_add_u32 m0, s91, 49152
    s_nop 0
    buffer_load_dwordx4 v11, s[24:27], s58 offen  lds
    s_getreg_b32 s18, hwreg(HW_REG_XCC_ID, 0, 4)
    s_waitcnt lgkmcnt(0)
    s_add_u32 s18, s18, s44
    s_add_u32 s18, s18, 1374496523
    s_add_u32 s44, s44, 2654435769
    s_waitcnt vmcnt(11)
    s_barrier
    s_bfe_u32 s61, s54, 196628
    s_add_u32 m0, s92, 106496
    s_mul_i32 s59, s61, 196608
    s_lshl_b32 s58, s61, 7
    buffer_load_dwordx4 v12, s[28:31], s59 offen offset:0  lds
    buffer_load_dwordx4 v12, s[28:31], s59 offen offset:1024  lds
    buffer_load_dwordx4 v12, s[28:31], s59 offen offset:2048  lds
    s_add_u32 m0, s88, 90112
    s_nop 0
    buffer_load_dwordx4 v8, s[24:27], s58 offen  lds
    s_mov_b32 m0, 5120
    s_mov_b64 exec, s[100:101]
    buffer_load_dwordx4 v14, s[24:27], s58 offen  lds
    s_add_u32 m0, s93, 106496
    s_mov_b64 exec, -1
    buffer_load_dwordx4 v13, s[28:31], s59 offen offset:0  lds
    buffer_load_dwordx4 v13, s[28:31], s59 offen offset:1024  lds
    buffer_load_dwordx4 v13, s[28:31], s59 offen offset:2048  lds
    s_add_u32 m0, s89, 90112
    s_nop 0
    buffer_load_dwordx4 v9, s[24:27], s58 offen  lds
    s_add_u32 m0, s90, 90112
    s_nop 0
    buffer_load_dwordx4 v10, s[24:27], s58 offen  lds
    s_add_u32 m0, s91, 90112
    s_nop 0
    buffer_load_dwordx4 v11, s[24:27], s58 offen  lds
    s_waitcnt vmcnt(11)
    s_barrier
    s_bfe_u32 s61, s54, 196632
    s_add_u32 m0, s92, 24576
    s_mul_i32 s59, s61, 196608
    s_lshl_b32 s58, s61, 7
    buffer_load_dwordx4 v12, s[28:31], s59 offen offset:0  lds
    buffer_load_dwordx4 v12, s[28:31], s59 offen offset:1024  lds
    buffer_load_dwordx4 v12, s[28:31], s59 offen offset:2048  lds
    s_add_u32 m0, s88, 8192
    s_nop 0
    buffer_load_dwordx4 v8, s[24:27], s58 offen  lds
    s_mov_b32 m0, 6144
    s_mov_b64 exec, s[100:101]
    buffer_load_dwordx4 v14, s[24:27], s58 offen  lds
    s_add_u32 m0, s93, 24576
    s_mov_b64 exec, -1
    buffer_load_dwordx4 v13, s[28:31], s59 offen offset:0  lds
    buffer_load_dwordx4 v13, s[28:31], s59 offen offset:1024  lds
    buffer_load_dwordx4 v13, s[28:31], s59 offen offset:2048  lds
    s_add_u32 m0, s89, 8192
    s_nop 0
    buffer_load_dwordx4 v9, s[24:27], s58 offen  lds
    s_add_u32 m0, s90, 8192
    s_nop 0
    buffer_load_dwordx4 v10, s[24:27], s58 offen  lds
    s_add_u32 m0, s91, 8192
    s_nop 0
    buffer_load_dwordx4 v11, s[24:27], s58 offen  lds
    s_add_u32 s61, s19, 8519680
    s_load_dwordx8 s[4:11], s[20:21], s61 glc
    s_waitcnt vmcnt(11)
    s_barrier
    s_bfe_u32 s61, s54, 196636
    s_add_u32 m0, s92, 65536
    s_mul_i32 s59, s61, 196608
    s_lshl_b32 s58, s61, 7
    buffer_load_dwordx4 v12, s[28:31], s59 offen offset:0  lds
    buffer_load_dwordx4 v12, s[28:31], s59 offen offset:1024  lds
    buffer_load_dwordx4 v12, s[28:31], s59 offen offset:2048  lds
    s_add_u32 m0, s88, 49152
    s_nop 0
    buffer_load_dwordx4 v8, s[24:27], s58 offen  lds
    s_mov_b32 m0, 7168
    s_mov_b64 exec, s[100:101]
    buffer_load_dwordx4 v14, s[24:27], s58 offen  lds
    s_add_u32 m0, s93, 65536
    s_mov_b64 exec, -1
    buffer_load_dwordx4 v13, s[28:31], s59 offen offset:0  lds
    buffer_load_dwordx4 v13, s[28:31], s59 offen offset:1024  lds
    buffer_load_dwordx4 v13, s[28:31], s59 offen offset:2048  lds
    s_add_u32 m0, s89, 49152
    s_nop 0
    buffer_load_dwordx4 v9, s[24:27], s58 offen  lds
    s_add_u32 m0, s90, 49152
    s_nop 0
    buffer_load_dwordx4 v10, s[24:27], s58 offen  lds
    s_add_u32 m0, s91, 49152
    s_nop 0
    buffer_load_dwordx4 v11, s[24:27], s58 offen  lds
    s_lshl_b32 s56, s55, 14
    s_waitcnt vmcnt(11)
    s_barrier
    s_add_u32 s58, s49, 0
    s_and_b32 s58, s58, 3
    s_lshl_b32 s59, s58, 12
    s_add_u32 s59, s59, s56
    s_add_u32 m0, s59, 98304
    s_lshl_b32 s58, s58, 15
    buffer_load_dwordx4 v246, s[32:35], s58 offen offset:0 lds
    buffer_load_dwordx4 v247, s[32:35], s58 offen offset:1024 lds
    buffer_load_dwordx4 v248, s[32:35], s58 offen offset:2048 lds
    buffer_load_dwordx4 v249, s[32:35], s58 offen offset:3072 lds
    s_add_u32 s58, s49, 1
    s_and_b32 s58, s58, 3
    s_lshl_b32 s59, s58, 12
    s_add_u32 s59, s59, s56
    s_add_u32 m0, s59, 98304
    s_lshl_b32 s58, s58, 15
    buffer_load_dwordx4 v246, s[32:35], s58 offen offset:0 lds
    buffer_load_dwordx4 v247, s[32:35], s58 offen offset:1024 lds
    buffer_load_dwordx4 v248, s[32:35], s58 offen offset:2048 lds
    buffer_load_dwordx4 v249, s[32:35], s58 offen offset:3072 lds
    s_waitcnt vmcnt(8)
    s_mov_b32 s19, s18
    s_waitcnt lgkmcnt(0)
    s_xor_b64 s[4:5], s[4:5], s[18:19]
    s_xor_b64 s[6:7], s[6:7], s[18:19]
    s_xor_b64 s[8:9], s[8:9], s[18:19]
    s_xor_b64 s[10:11], s[10:11], s[18:19]
    s_or_b64 s[4:5], s[4:5], s[6:7]
    s_or_b64 s[8:9], s[8:9], s[10:11]
    s_or_b64 s[4:5], s[4:5], s[8:9]
    s_cselect_b32 s4, 0, 1
    v_mov_b32 v1, 0
    v_mov_b32 v2, s4
    ds_write_b32 v1, v2
    s_lshl_b32 s5, s55, 2
    v_mov_b32 v3, s5
    ds_write_b32 v3, v1 offset:16
    s_waitcnt lgkmcnt(0)
    s_barrier
    s_add_u32 s58, s49, 2
    s_and_b32 s58, s58, 3
    s_lshl_b32 s59, s58, 12
    s_add_u32 s59, s59, s56
    s_add_u32 m0, s59, 98304
    s_lshl_b32 s58, s58, 15
    buffer_load_dwordx4 v246, s[32:35], s58 offen offset:0 lds
    buffer_load_dwordx4 v247, s[32:35], s58 offen offset:1024 lds
    buffer_load_dwordx4 v248, s[32:35], s58 offen offset:2048 lds
    buffer_load_dwordx4 v249, s[32:35], s58 offen offset:3072 lds
    s_add_u32 s58, s49, 3
    s_and_b32 s58, s58, 3
    s_lshl_b32 s59, s58, 12
    s_add_u32 s59, s59, s56
    s_add_u32 m0, s59, 98304
    s_lshl_b32 s58, s58, 15
    buffer_load_dwordx4 v246, s[32:35], s58 offen offset:0 lds
    buffer_load_dwordx4 v247, s[32:35], s58 offen offset:1024 lds
    buffer_load_dwordx4 v248, s[32:35], s58 offen offset:2048 lds
    buffer_load_dwordx4 v249, s[32:35], s58 offen offset:3072 lds
    buffer_load_dword v235, v234, s[40:43], s45 offen sc1
    s_mov_b32 s47, 2097152
    s_waitcnt vmcnt(1)
    v_mov_b32 v2, 1
    ds_write_b32 v3, v2 offset:16
    v_mov_b32 v242, 0
    s_waitcnt vmcnt(0)
    v_cmp_ne_u32 vcc, s44, v235
    s_cbranch_vccnz L_pre
    buffer_load_dword v235, v234, s[40:43], s45 offen offset:32 sc1
    buffer_load_dwordx4 v[0:3], v232, s[40:43], s12 offen offset:0 sc1
    buffer_load_dwordx4 v[4:7], v232, s[40:43], s12 offen offset:1024 sc1
    buffer_load_dwordx4 v[8:11], v232, s[40:43], s12 offen offset:2048 sc1
    buffer_load_dwordx4 v[12:15], v232, s[40:43], s12 offen offset:3072 sc1
    buffer_load_dwordx4 v[16:19], v233, s[40:43], s12 offen offset:0 sc1
    buffer_load_dwordx4 v[20:23], v233, s[40:43], s12 offen offset:1024 sc1
    buffer_load_dwordx4 v[24:27], v233, s[40:43], s12 offen offset:2048 sc1
    buffer_load_dwordx4 v[28:31], v233, s[40:43], s12 offen offset:3072 sc1
L_ls:
    ds_read_b128 v[160:163], v242 offset:16
    s_sub_u32 s47, s47, 1
    s_cmp_lt_i32 s47, 0
    s_cbranch_scc1 L_lsx
    s_waitcnt lgkmcnt(0)
    v_and_b32 v160, v160, v161
    v_and_b32 v162, v162, v163
    v_and_b32 v160, v160, v162
    v_cmp_eq_u32 vcc, 0, v160
    s_cbranch_vccnz L_ls
L_lsx:
    ds_read_b64_tr_b16 v[160:161], v224 offset:0
    ds_read_b64_tr_b16 v[162:163], v224 offset:512
    ds_read_b64_tr_b16 v[164:165], v225 offset:0
    ds_read_b64_tr_b16 v[166:167], v225 offset:512
    ds_read_b64_tr_b16 v[168:169], v224 offset:2048
    ds_read_b64_tr_b16 v[170:171], v224 offset:2560
    ds_read_b64_tr_b16 v[172:173], v225 offset:2048
    ds_read_b64_tr_b16 v[174:175], v225 offset:2560
    ds_read_b64_tr_b16 v[176:177], v224 offset:4096
    ds_read_b64_tr_b16 v[178:179], v224 offset:4608
    ds_read_b64_tr_b16 v[180:181], v225 offset:4096
    ds_read_b64_tr_b16 v[182:183], v225 offset:4608
    ds_read_b64_tr_b16 v[184:185], v224 offset:6144
    ds_read_b64_tr_b16 v[186:187], v224 offset:6656
    s_waitcnt lgkmcnt(10)
    ds_read_b64_tr_b16 v[188:189], v225 offset:6144
    ds_read_b64_tr_b16 v[190:191], v225 offset:6656
    ds_read_b64_tr_b16 v[192:193], v224 offset:32768
    ds_read_b64_tr_b16 v[194:195], v224 offset:33280
    s_waitcnt lgkmcnt(10)
    ds_read_b64_tr_b16 v[196:197], v225 offset:32768
    ds_read_b64_tr_b16 v[198:199], v225 offset:33280
    ds_read_b64_tr_b16 v[200:201], v224 offset:34816
    ds_read_b64_tr_b16 v[202:203], v224 offset:35328
    s_waitcnt lgkmcnt(10)
    ds_read_b64_tr_b16 v[204:205], v225 offset:34816
    ds_read_b64_tr_b16 v[206:207], v225 offset:35328
    ds_read_b64_tr_b16 v[208:209], v224 offset:36864
    ds_read_b64_tr_b16 v[210:211], v224 offset:37376
    s_waitcnt lgkmcnt(10)
    ds_read_b64_tr_b16 v[212:213], v225 offset:36864
    ds_read_b64_tr_b16 v[214:215], v225 offset:37376
L_prej:
    s_waitcnt vmcnt(8)
    v_cmp_ne_u32 vcc, s44, v235
    s_cbranch_vccnz L_alt0
    buffer_load_dword v235, v234, s[40:43], s45 offen offset:64 sc1
    s_waitcnt vmcnt(8)
    v_mfma_f32_32x32x16_bf16 v[128:143], v[160:163], v[0:3], 0
    buffer_load_dwordx4 v[32:35], v232, s[40:43], s13 offen offset:0 sc1
    ds_read_b64_tr_b16 v[216:217], v224 offset:38912
    ds_read_b64_tr_b16 v[218:219], v224 offset:39424
    v_mfma_f32_32x32x16_bf16 v[144:159], v[164:167], v[0:3], 0
    buffer_load_dwordx4 v[36:39], v232, s[40:43], s13 offen offset:1024 sc1
    s_waitcnt lgkmcnt(10)
    ds_read_b64_tr_b16 v[220:221], v225 offset:38912
    ds_read_b64_tr_b16 v[222:223], v225 offset:39424
    s_waitcnt vmcnt(9)
    v_mfma_f32_32x32x16_bf16 v[128:143], v[168:171], v[4:7], v[128:143]
    buffer_load_dwordx4 v[40:43], v232, s[40:43], s13 offen offset:2048 sc1
    ds_read_b64_tr_b16 v[160:161], v226 offset:0
    ds_read_b64_tr_b16 v[162:163], v226 offset:512
    v_mfma_f32_32x32x16_bf16 v[144:159], v[172:175], v[4:7], v[144:159]
    s_waitcnt lgkmcnt(10)
    ds_read_b64_tr_b16 v[164:165], v227 offset:0
    ds_read_b64_tr_b16 v[166:167], v227 offset:512
    s_waitcnt vmcnt(9)
    v_mfma_f32_32x32x16_bf16 v[128:143], v[176:179], v[8:11], v[128:143]
    buffer_load_dwordx4 v[44:47], v232, s[40:43], s13 offen offset:3072 sc1
    ds_read_b64_tr_b16 v[168:169], v226 offset:2048
    ds_read_b64_tr_b16 v[170:171], v226 offset:2560
    v_mfma_f32_32x32x16_bf16 v[144:159], v[180:183], v[8:11], v[144:159]
    buffer_load_dwordx4 v[48:51], v233, s[40:43], s13 offen offset:0 sc1
    s_waitcnt lgkmcnt(10)
    ds_read_b64_tr_b16 v[172:173], v227 offset:2048
    ds_read_b64_tr_b16 v[174:175], v227 offset:2560
    s_waitcnt vmcnt(10)
    v_mfma_f32_32x32x16_bf16 v[128:143], v[184:187], v[12:15], v[128:143]
    buffer_load_dwordx4 v[52:55], v233, s[40:43], s13 offen offset:1024 sc1
    ds_read_b64_tr_b16 v[176:177], v226 offset:4096
    ds_read_b64_tr_b16 v[178:179], v226 offset:4608
    v_mfma_f32_32x32x16_bf16 v[144:159], v[188:191], v[12:15], v[144:159]
    s_waitcnt lgkmcnt(10)
    ds_read_b64_tr_b16 v[180:181], v227 offset:4096
    ds_read_b64_tr_b16 v[182:183], v227 offset:4608
    s_waitcnt vmcnt(10)
    v_mfma_f32_32x32x16_bf16 v[128:143], v[192:195], v[16:19], v[128:143]
    buffer_load_dwordx4 v[56:59], v233, s[40:43], s13 offen offset:2048 sc1
    ds_read_b64_tr_b16 v[184:185], v226 offset:6144
    ds_read_b64_tr_b16 v[186:187], v226 offset:6656
    v_mfma_f32_32x32x16_bf16 v[144:159], v[196:199], v[16:19], v[144:159]
    buffer_load_dwordx4 v[60:63], v233, s[40:43], s13 offen offset:3072 sc1
    s_waitcnt lgkmcnt(10)
    ds_read_b64_tr_b16 v[188:189], v227 offset:6144
    ds_read_b64_tr_b16 v[190:191], v227 offset:6656
    s_waitcnt vmcnt(11)
    v_mfma_f32_32x32x16_bf16 v[128:143], v[200:203], v[20:23], v[128:143]
    ds_read_b64_tr_b16 v[192:193], v226 offset:32768
    ds_read_b64_tr_b16 v[194:195], v226 offset:33280
    v_mfma_f32_32x32x16_bf16 v[144:159], v[204:207], v[20:23], v[144:159]
    s_waitcnt lgkmcnt(10)
    ds_read_b64_tr_b16 v[196:197], v227 offset:32768
    ds_read_b64_tr_b16 v[198:199], v227 offset:33280
    s_waitcnt vmcnt(10)
    v_mfma_f32_32x32x16_bf16 v[128:143], v[208:211], v[24:27], v[128:143]
    ds_read_b64_tr_b16 v[200:201], v226 offset:34816
    ds_read_b64_tr_b16 v[202:203], v226 offset:35328
    v_mfma_f32_32x32x16_bf16 v[144:159], v[212:215], v[24:27], v[144:159]
    s_waitcnt lgkmcnt(10)
    ds_read_b64_tr_b16 v[204:205], v227 offset:34816
    ds_read_b64_tr_b16 v[206:207], v227 offset:35328
    s_waitcnt vmcnt(9)
    v_mfma_f32_32x32x16_bf16 v[128:143], v[216:219], v[28:31], v[128:143]
    ds_read_b64_tr_b16 v[208:209], v226 offset:36864
    ds_read_b64_tr_b16 v[210:211], v226 offset:37376
    v_mfma_f32_32x32x16_bf16 v[144:159], v[220:223], v[28:31], v[144:159]
    s_waitcnt lgkmcnt(10)
    ds_read_b64_tr_b16 v[212:213], v227 offset:36864
    ds_read_b64_tr_b16 v[214:215], v227 offset:37376
L_join0:
    s_waitcnt vmcnt(8)
    v_cmp_ne_u32 vcc, s44, v235
    s_cbranch_vccnz L_alt1
    buffer_load_dword v235, v234, s[40:43], s45 offen offset:96 sc1
    s_waitcnt vmcnt(8)
    v_mfma_f32_32x32x16_bf16 v[128:143], v[160:163], v[32:35], v[128:143]
    buffer_load_dwordx4 v[64:67], v232, s[40:43], s14 offen offset:0 sc1
    ds_read_b64_tr_b16 v[216:217], v226 offset:38912
    ds_read_b64_tr_b16 v[218:219], v226 offset:39424
    v_mfma_f32_32x32x16_bf16 v[144:159], v[164:167], v[32:35], v[144:159]
    buffer_load_dwordx4 v[68:71], v232, s[40:43], s14 offen offset:1024 sc1
    s_waitcnt lgkmcnt(10)
    ds_read_b64_tr_b16 v[220:221], v227 offset:38912
    ds_read_b64_tr_b16 v[222:223], v227 offset:39424
    s_waitcnt vmcnt(9)
    v_mfma_f32_32x32x16_bf16 v[128:143], v[168:171], v[36:39], v[128:143]
    buffer_load_dwordx4 v[72:75], v232, s[40:43], s14 offen offset:2048 sc1
    ds_read_b64_tr_b16 v[160:161], v228 offset:0
    ds_read_b64_tr_b16 v[162:163], v228 offset:512
    v_mfma_f32_32x32x16_bf16 v[144:159], v[172:175], v[36:39], v[144:159]
    s_waitcnt lgkmcnt(10)
    ds_read_b64_tr_b16 v[164:165], v229 offset:0
    ds_read_b64_tr_b16 v[166:167], v229 offset:512
    s_waitcnt vmcnt(9)
    v_mfma_f32_32x32x16_bf16 v[128:143], v[176:179], v[40:43], v[128:143]
    buffer_load_dwordx4 v[76:79], v232, s[40:43], s14 offen offset:3072 sc1
    ds_read_b64_tr_b16 v[168:169], v228 offset:2048
    ds_read_b64_tr_b16 v[170:171], v228 offset:2560
    v_mfma_f32_32x32x16_bf16 v[144:159], v[180:183], v[40:43], v[144:159]
    buffer_load_dwordx4 v[80:83], v233, s[40:43], s14 offen offset:0 sc1
    s_waitcnt lgkmcnt(10)
    ds_read_b64_tr_b16 v[172:173], v229 offset:2048
    ds_read_b64_tr_b16 v[174:175], v229 offset:2560
    s_waitcnt vmcnt(10)
    v_mfma_f32_32x32x16_bf16 v[128:143], v[184:187], v[44:47], v[128:143]
    buffer_load_dwordx4 v[84:87], v233, s[40:43], s14 offen offset:1024 sc1
    ds_read_b64_tr_b16 v[176:177], v228 offset:4096
    ds_read_b64_tr_b16 v[178:179], v228 offset:4608
    v_mfma_f32_32x32x16_bf16 v[144:159], v[188:191], v[44:47], v[144:159]
    s_waitcnt lgkmcnt(10)
    ds_read_b64_tr_b16 v[180:181], v229 offset:4096
    ds_read_b64_tr_b16 v[182:183], v229 offset:4608
    s_waitcnt vmcnt(10)
    v_mfma_f32_32x32x16_bf16 v[128:143], v[192:195], v[48:51], v[128:143]
    buffer_load_dwordx4 v[88:91], v233, s[40:43], s14 offen offset:2048 sc1
    ds_read_b64_tr_b16 v[184:185], v228 offset:6144
    ds_read_b64_tr_b16 v[186:187], v228 offset:6656
    v_mfma_f32_32x32x16_bf16 v[144:159], v[196:199], v[48:51], v[144:159]
    buffer_load_dwordx4 v[92:95], v233, s[40:43], s14 offen offset:3072 sc1
    s_waitcnt lgkmcnt(10)
    ds_read_b64_tr_b16 v[188:189], v229 offset:6144
    ds_read_b64_tr_b16 v[190:191], v229 offset:6656
    s_waitcnt vmcnt(11)
    v_mfma_f32_32x32x16_bf16 v[128:143], v[200:203], v[52:55], v[128:143]
    ds_read_b64_tr_b16 v[192:193], v228 offset:32768
    ds_read_b64_tr_b16 v[194:195], v228 offset:33280
    v_mfma_f32_32x32x16_bf16 v[144:159], v[204:207], v[52:55], v[144:159]
    s_waitcnt lgkmcnt(10)
    ds_read_b64_tr_b16 v[196:197], v229 offset:32768
    ds_read_b64_tr_b16 v[198:199], v229 offset:33280
    s_waitcnt vmcnt(10)
    v_mfma_f32_32x32x16_bf16 v[128:143], v[208:211], v[56:59], v[128:143]
    ds_read_b64_tr_b16 v[200:201], v228 offset:34816
    ds_read_b64_tr_b16 v[202:203], v228 offset:35328
    v_mfma_f32_32x32x16_bf16 v[144:159], v[212:215], v[56:59], v[144:159]
    s_waitcnt lgkmcnt(10)
    ds_read_b64_tr_b16 v[204:205], v229 offset:34816
    ds_read_b64_tr_b16 v[206:207], v229 offset:35328
    s_waitcnt vmcnt(9)
    v_mfma_f32_32x32x16_bf16 v[128:143], v[216:219], v[60:63], v[128:143]
    ds_read_b64_tr_b16 v[208:209], v228 offset:36864
    ds_read_b64_tr_b16 v[210:211], v228 offset:37376
    v_mfma_f32_32x32x16_bf16 v[144:159], v[220:223], v[60:63], v[144:159]
    s_waitcnt lgkmcnt(10)
    ds_read_b64_tr_b16 v[212:213], v229 offset:36864
    ds_read_b64_tr_b16 v[214:215], v229 offset:37376
L_join1:
    s_waitcnt vmcnt(8)
    v_cmp_ne_u32 vcc, s44, v235
    s_cbranch_vccnz L_alt2
    buffer_load_dwordx4 v[96:99], v232, s[40:43], s15 offen offset:0 sc1
    s_waitcnt vmcnt(8)
    v_mfma_f32_32x32x16_bf16 v[128:143], v[160:163], v[64:67], v[128:143]
    buffer_load_dwordx4 v[100:103], v232, s[40:43], s15 offen offset:1024 sc1
    ds_read_b64_tr_b16 v[216:217], v228 offset:38912
    ds_read_b64_tr_b16 v[218:219], v228 offset:39424
    v_mfma_f32_32x32x16_bf16 v[144:159], v[164:167], v[64:67], v[144:159]
    buffer_load_dwordx4 v[104:107], v232, s[40:43], s15 offen offset:2048 sc1
    s_waitcnt lgkmcnt(10)
    ds_read_b64_tr_b16 v[220:221], v229 offset:38912
    ds_read_b64_tr_b16 v[222:223], v229 offset:39424
    s_waitcnt vmcnt(9)
    v_mfma_f32_32x32x16_bf16 v[128:143], v[168:171], v[68:71], v[128:143]
    buffer_load_dwordx4 v[108:111], v232, s[40:43], s15 offen offset:3072 sc1
    ds_read_b64_tr_b16 v[160:161], v230 offset:0
    ds_read_b64_tr_b16 v[162:163], v230 offset:512
    v_mfma_f32_32x32x16_bf16 v[144:159], v[172:175], v[68:71], v[144:159]
    s_waitcnt lgkmcnt(10)
    ds_read_b64_tr_b16 v[164:165], v231 offset:0
    ds_read_b64_tr_b16 v[166:167], v231 offset:512
    s_waitcnt vmcnt(9)
    v_mfma_f32_32x32x16_bf16 v[128:143], v[176:179], v[72:75], v[128:143]
    buffer_load_dwordx4 v[112:115], v233, s[40:43], s15 offen offset:0 sc1
    ds_read_b64_tr_b16 v[168:169], v230 offset:2048
    ds_read_b64_tr_b16 v[170:171], v230 offset:2560
    v_mfma_f32_32x32x16_bf16 v[144:159], v[180:183], v[72:75], v[144:159]
    buffer_load_dwordx4 v[116:119], v233, s[40:43], s15 offen offset:1024 sc1
    s_waitcnt lgkmcnt(10)
    ds_read_b64_tr_b16 v[172:173], v231 offset:2048
    ds_read_b64_tr_b16 v[174:175], v231 offset:2560
    s_waitcnt vmcnt(10)
    v_mfma_f32_32x32x16_bf16 v[128:143], v[184:187], v[76:79], v[128:143]
    buffer_load_dwordx4 v[120:123], v233, s[40:43], s15 offen offset:2048 sc1
    ds_read_b64_tr_b16 v[176:177], v230 offset:4096
    ds_read_b64_tr_b16 v[178:179], v230 offset:4608
    v_mfma_f32_32x32x16_bf16 v[144:159], v[188:191], v[76:79], v[144:159]
    s_waitcnt lgkmcnt(10)
    ds_read_b64_tr_b16 v[180:181], v231 offset:4096
    ds_read_b64_tr_b16 v[182:183], v231 offset:4608
    s_waitcnt vmcnt(10)
    v_mfma_f32_32x32x16_bf16 v[128:143], v[192:195], v[80:83], v[128:143]
    buffer_load_dwordx4 v[124:127], v233, s[40:43], s15 offen offset:3072 sc1
    ds_read_b64_tr_b16 v[184:185], v230 offset:6144
    ds_read_b64_tr_b16 v[186:187], v230 offset:6656
    v_mfma_f32_32x32x16_bf16 v[144:159], v[196:199], v[80:83], v[144:159]
    s_waitcnt lgkmcnt(10)
    ds_read_b64_tr_b16 v[188:189], v231 offset:6144
    ds_read_b64_tr_b16 v[190:191], v231 offset:6656
    s_waitcnt vmcnt(10)
    v_mfma_f32_32x32x16_bf16 v[128:143], v[200:203], v[84:87], v[128:143]
    ds_read_b64_tr_b16 v[192:193], v230 offset:32768
    ds_read_b64_tr_b16 v[194:195], v230 offset:33280
    v_mfma_f32_32x32x16_bf16 v[144:159], v[204:207], v[84:87], v[144:159]
    s_waitcnt lgkmcnt(10)
    ds_read_b64_tr_b16 v[196:197], v231 offset:32768
    ds_read_b64_tr_b16 v[198:199], v231 offset:33280
    s_waitcnt vmcnt(9)
    v_mfma_f32_32x32x16_bf16 v[128:143], v[208:211], v[88:91], v[128:143]
    ds_read_b64_tr_b16 v[200:201], v230 offset:34816
    ds_read_b64_tr_b16 v[202:203], v230 offset:35328
    v_mfma_f32_32x32x16_bf16 v[144:159], v[212:215], v[88:91], v[144:159]
    s_waitcnt lgkmcnt(10)
    ds_read_b64_tr_b16 v[204:205], v231 offset:34816
    ds_read_b64_tr_b16 v[206:207], v231 offset:35328
    s_waitcnt vmcnt(8)
    v_mfma_f32_32x32x16_bf16 v[128:143], v[216:219], v[92:95], v[128:143]
    ds_read_b64_tr_b16 v[208:209], v230 offset:36864
    ds_read_b64_tr_b16 v[210:211], v230 offset:37376
    v_mfma_f32_32x32x16_bf16 v[144:159], v[220:223], v[92:95], v[144:159]
    s_waitcnt lgkmcnt(10)
    ds_read_b64_tr_b16 v[212:213], v231 offset:36864
    ds_read_b64_tr_b16 v[214:215], v231 offset:37376
L_join2:
    s_waitcnt vmcnt(7)
    v_mfma_f32_32x32x16_bf16 v[128:143], v[160:163], v[96:99], v[128:143]
    ds_read_b64_tr_b16 v[216:217], v230 offset:38912
    ds_read_b64_tr_b16 v[218:219], v230 offset:39424
    v_mfma_f32_32x32x16_bf16 v[144:159], v[164:167], v[96:99], v[144:159]
    s_waitcnt lgkmcnt(10)
    ds_read_b64_tr_b16 v[220:221], v231 offset:38912
    ds_read_b64_tr_b16 v[222:223], v231 offset:39424
    s_waitcnt vmcnt(6)
    v_mfma_f32_32x32x16_bf16 v[128:143], v[168:171], v[100:103], v[128:143]
    v_mfma_f32_32x32x16_bf16 v[144:159], v[172:175], v[100:103], v[144:159]
    s_waitcnt vmcnt(5)
    v_mfma_f32_32x32x16_bf16 v[128:143], v[176:179], v[104:107], v[128:143]
    v_mfma_f32_32x32x16_bf16 v[144:159], v[180:183], v[104:107], v[144:159]
    s_waitcnt vmcnt(4)
    v_mfma_f32_32x32x16_bf16 v[128:143], v[184:187], v[108:111], v[128:143]
    v_mfma_f32_32x32x16_bf16 v[144:159], v[188:191], v[108:111], v[144:159]
    s_waitcnt vmcnt(3)
    v_mfma_f32_32x32x16_bf16 v[128:143], v[192:195], v[112:115], v[128:143]
    v_mfma_f32_32x32x16_bf16 v[144:159], v[196:199], v[112:115], v[144:159]
    s_waitcnt vmcnt(2) lgkmcnt(8)
    v_mfma_f32_32x32x16_bf16 v[128:143], v[200:203], v[116:119], v[128:143]
    v_mfma_f32_32x32x16_bf16 v[144:159], v[204:207], v[116:119], v[144:159]
    s_waitcnt vmcnt(1) lgkmcnt(4)
    v_mfma_f32_32x32x16_bf16 v[128:143], v[208:211], v[120:123], v[128:143]
    v_mfma_f32_32x32x16_bf16 v[144:159], v[212:215], v[120:123], v[144:159]
    s_waitcnt vmcnt(0) lgkmcnt(0)
    v_mfma_f32_32x32x16_bf16 v[128:143], v[216:219], v[124:127], v[128:143]
    v_mfma_f32_32x32x16_bf16 v[144:159], v[220:223], v[124:127], v[144:159]
    s_nop 10
    v_cvt_pk_bf16_f32 v0, v128, v129
    v_cvt_pk_bf16_f32 v1, v130, v131
    v_cvt_pk_bf16_f32 v2, v132, v133
    v_cvt_pk_bf16_f32 v3, v134, v135
    ds_write_b128 v236, v[0:3]
    v_cvt_pk_bf16_f32 v4, v136, v137
    v_cvt_pk_bf16_f32 v5, v138, v139
    v_cvt_pk_bf16_f32 v6, v140, v141
    v_cvt_pk_bf16_f32 v7, v142, v143
    ds_write_b128 v237, v[4:7]
    v_cvt_pk_bf16_f32 v8, v144, v145
    v_cvt_pk_bf16_f32 v9, v146, v147
    v_cvt_pk_bf16_f32 v10, v148, v149
    v_cvt_pk_bf16_f32 v11, v150, v151
    ds_write_b128 v238, v[8:11]
    v_cvt_pk_bf16_f32 v12, v152, v153
    v_cvt_pk_bf16_f32 v13, v154, v155
    v_cvt_pk_bf16_f32 v14, v156, v157
    v_cvt_pk_bf16_f32 v15, v158, v159
    ds_write_b128 v239, v[12:15]
    s_waitcnt lgkmcnt(0)
    ds_read_b128 v[16:19], v240 offset:0
    ds_read_b128 v[20:23], v240 offset:1024
    ds_read_b128 v[24:27], v240 offset:2048
    ds_read_b128 v[28:31], v240 offset:3072
    s_waitcnt lgkmcnt(3)
    buffer_store_dwordx4 v[16:19], v241, s[36:39], s46 offen nt
    s_waitcnt lgkmcnt(2)
    s_add_u32 s46, s46, 32768
    buffer_store_dwordx4 v[20:23], v241, s[36:39], s46 offen nt
    s_waitcnt lgkmcnt(1)
    s_add_u32 s46, s46, 32768
    buffer_store_dwordx4 v[24:27], v241, s[36:39], s46 offen nt
    s_waitcnt lgkmcnt(0)
    s_add_u32 s46, s46, 32768
    buffer_store_dwordx4 v[28:31], v241, s[36:39], s46 offen nt
    s_or_b32 s61, s50, s55
    s_cbranch_scc0 L_epoch
L_epochx:
L_end:
    s_endpgm
L_spin0:
    s_sub_u32 s47, s47, 1
    s_cmp_lt_i32 s47, 0
    s_cbranch_scc1 L_ok0
    buffer_load_dword v235, v234, s[40:43], s45 offen offset:0 sc1
    s_waitcnt vmcnt(0)
    s_branch L_chk0
L_spin1:
    s_sub_u32 s47, s47, 1
    s_cmp_lt_i32 s47, 0
    s_cbranch_scc1 L_ok1
    buffer_load_dword v235, v234, s[40:43], s45 offen offset:32 sc1
    s_waitcnt vmcnt(0)
    s_branch L_chk1
L_spin2:
    s_sub_u32 s47, s47, 1
    s_cmp_lt_i32 s47, 0
    s_cbranch_scc1 L_ok2
    buffer_load_dword v235, v234, s[40:43], s45 offen offset:64 sc1
    s_waitcnt vmcnt(0)
    s_branch L_chk2
L_spin3:
    s_sub_u32 s47, s47, 1
    s_cmp_lt_i32 s47, 0
    s_cbranch_scc1 L_ok3
    buffer_load_dword v235, v234, s[40:43], s45 offen offset:96 sc1
    s_waitcnt vmcnt(0)
    s_branch L_chk3
L_alt0:
    s_waitcnt vmcnt(7)
    v_mfma_f32_32x32x16_bf16 v[128:143], v[160:163], v[0:3], 0
    ds_read_b64_tr_b16 v[216:217], v224 offset:38912
    ds_read_b64_tr_b16 v[218:219], v224 offset:39424
    v_mfma_f32_32x32x16_bf16 v[144:159], v[164:167], v[0:3], 0
    s_waitcnt lgkmcnt(10)
    ds_read_b64_tr_b16 v[220:221], v225 offset:38912
    ds_read_b64_tr_b16 v[222:223], v225 offset:39424
    s_waitcnt vmcnt(6)
    v_mfma_f32_32x32x16_bf16 v[128:143], v[168:171], v[4:7], v[128:143]
    ds_read_b64_tr_b16 v[160:161], v226 offset:0
    ds_read_b64_tr_b16 v[162:163], v226 offset:512
    v_mfma_f32_32x32x16_bf16 v[144:159], v[172:175], v[4:7], v[144:159]
    s_waitcnt lgkmcnt(10)
    ds_read_b64_tr_b16 v[164:165], v227 offset:0
    ds_read_b64_tr_b16 v[166:167], v227 offset:512
    s_waitcnt vmcnt(5)
    v_mfma_f32_32x32x16_bf16 v[128:143], v[176:179], v[8:11], v[128:143]
    buffer_load_dword v235, v234, s[40:43], s45 offen offset:32 sc1
    ds_read_b64_tr_b16 v[168:169], v226 offset:2048
    ds_read_b64_tr_b16 v[170:171], v226 offset:2560
    v_mfma_f32_32x32x16_bf16 v[144:159], v[180:183], v[8:11], v[144:159]
    s_waitcnt lgkmcnt(10)
    ds_read_b64_tr_b16 v[172:173], v227 offset:2048
    ds_read_b64_tr_b16 v[174:175], v227 offset:2560
    s_waitcnt vmcnt(5)
    v_mfma_f32_32x32x16_bf16 v[128:143], v[184:187], v[12:15], v[128:143]
    ds_read_b64_tr_b16 v[176:177], v226 offset:4096
    ds_read_b64_tr_b16 v[178:179], v226 offset:4608
    v_mfma_f32_32x32x16_bf16 v[144:159], v[188:191], v[12:15], v[144:159]
    s_waitcnt lgkmcnt(10)
    ds_read_b64_tr_b16 v[180:181], v227 offset:4096
    ds_read_b64_tr_b16 v[182:183], v227 offset:4608
    s_waitcnt vmcnt(4)
    v_mfma_f32_32x32x16_bf16 v[128:143], v[192:195], v[16:19], v[128:143]
    ds_read_b64_tr_b16 v[184:185], v226 offset:6144
    ds_read_b64_tr_b16 v[186:187], v226 offset:6656
    v_mfma_f32_32x32x16_bf16 v[144:159], v[196:199], v[16:19], v[144:159]
    s_waitcnt lgkmcnt(10)
    ds_read_b64_tr_b16 v[188:189], v227 offset:6144
    ds_read_b64_tr_b16 v[190:191], v227 offset:6656
    s_waitcnt vmcnt(3)
    v_mfma_f32_32x32x16_bf16 v[128:143], v[200:203], v[20:23], v[128:143]
    ds_read_b64_tr_b16 v[192:193], v226 offset:32768
    ds_read_b64_tr_b16 v[194:195], v226 offset:33280
    v_mfma_f32_32x32x16_bf16 v[144:159], v[204:207], v[20:23], v[144:159]
    s_waitcnt lgkmcnt(10)
    ds_read_b64_tr_b16 v[196:197], v227 offset:32768
    ds_read_b64_tr_b16 v[198:199], v227 offset:33280
    s_waitcnt vmcnt(2)
    v_mfma_f32_32x32x16_bf16 v[128:143], v[208:211], v[24:27], v[128:143]
    ds_read_b64_tr_b16 v[200:201], v226 offset:34816
    ds_read_b64_tr_b16 v[202:203], v226 offset:35328
    v_mfma_f32_32x32x16_bf16 v[144:159], v[212:215], v[24:27], v[144:159]
    s_waitcnt lgkmcnt(10)
    ds_read_b64_tr_b16 v[204:205], v227 offset:34816
    ds_read_b64_tr_b16 v[206:207], v227 offset:35328
    s_waitcnt vmcnt(1)
    v_mfma_f32_32x32x16_bf16 v[128:143], v[216:219], v[28:31], v[128:143]
    ds_read_b64_tr_b16 v[208:209], v226 offset:36864
    ds_read_b64_tr_b16 v[210:211], v226 offset:37376
    v_mfma_f32_32x32x16_bf16 v[144:159], v[220:223], v[28:31], v[144:159]
    s_waitcnt lgkmcnt(10)
    ds_read_b64_tr_b16 v[212:213], v227 offset:36864
    ds_read_b64_tr_b16 v[214:215], v227 offset:37376
    s_waitcnt vmcnt(0)
L_chk1:
    v_cmp_ne_u32 vcc, s44, v235
    s_cbranch_vccnz L_spin1
L_ok1:
    buffer_load_dword v235, v234, s[40:43], s45 offen offset:64 sc1
    buffer_load_dwordx4 v[32:35], v232, s[40:43], s13 offen offset:0 sc1
    buffer_load_dwordx4 v[36:39], v232, s[40:43], s13 offen offset:1024 sc1
    buffer_load_dwordx4 v[40:43], v232, s[40:43], s13 offen offset:2048 sc1
    buffer_load_dwordx4 v[44:47], v232, s[40:43], s13 offen offset:3072 sc1
    buffer_load_dwordx4 v[48:51], v233, s[40:43], s13 offen offset:0 sc1
    buffer_load_dwordx4 v[52:55], v233, s[40:43], s13 offen offset:1024 sc1
    buffer_load_dwordx4 v[56:59], v233, s[40:43], s13 offen offset:2048 sc1
    buffer_load_dwordx4 v[60:63], v233, s[40:43], s13 offen offset:3072 sc1
    s_branch L_join0
L_alt1:
    s_waitcnt vmcnt(7)
    v_mfma_f32_32x32x16_bf16 v[128:143], v[160:163], v[32:35], v[128:143]
    ds_read_b64_tr_b16 v[216:217], v226 offset:38912
    ds_read_b64_tr_b16 v[218:219], v226 offset:39424
    v_mfma_f32_32x32x16_bf16 v[144:159], v[164:167], v[32:35], v[144:159]
    s_waitcnt lgkmcnt(10)
    ds_read_b64_tr_b16 v[220:221], v227 offset:38912
    ds_read_b64_tr_b16 v[222:223], v227 offset:39424
    s_waitcnt vmcnt(6)
    v_mfma_f32_32x32x16_bf16 v[128:143], v[168:171], v[36:39], v[128:143]
    ds_read_b64_tr_b16 v[160:161], v228 offset:0
    ds_read_b64_tr_b16 v[162:163], v228 offset:512
    v_mfma_f32_32x32x16_bf16 v[144:159], v[172:175], v[36:39], v[144:159]
    s_waitcnt lgkmcnt(10)
    ds_read_b64_tr_b16 v[164:165], v229 offset:0
    ds_read_b64_tr_b16 v[166:167], v229 offset:512
    s_waitcnt vmcnt(5)
    v_mfma_f32_32x32x16_bf16 v[128:143], v[176:179], v[40:43], v[128:143]
    buffer_load_dword v235, v234, s[40:43], s45 offen offset:64 sc1
    ds_read_b64_tr_b16 v[168:169], v228 offset:2048
    ds_read_b64_tr_b16 v[170:171], v228 offset:2560
    v_mfma_f32_32x32x16_bf16 v[144:159], v[180:183], v[40:43], v[144:159]
    s_waitcnt lgkmcnt(10)
    ds_read_b64_tr_b16 v[172:173], v229 offset:2048
    ds_read_b64_tr_b16 v[174:175], v229 offset:2560
    s_waitcnt vmcnt(5)
    v_mfma_f32_32x32x16_bf16 v[128:143], v[184:187], v[44:47], v[128:143]
    ds_read_b64_tr_b16 v[176:177], v228 offset:4096
    ds_read_b64_tr_b16 v[178:179], v228 offset:4608
    v_mfma_f32_32x32x16_bf16 v[144:159], v[188:191], v[44:47], v[144:159]
    s_waitcnt lgkmcnt(10)
    ds_read_b64_tr_b16 v[180:181], v229 offset:4096
    ds_read_b64_tr_b16 v[182:183], v229 offset:4608
    s_waitcnt vmcnt(4)
    v_mfma_f32_32x32x16_bf16 v[128:143], v[192:195], v[48:51], v[128:143]
    ds_read_b64_tr_b16 v[184:185], v228 offset:6144
    ds_read_b64_tr_b16 v[186:187], v228 offset:6656
    v_mfma_f32_32x32x16_bf16 v[144:159], v[196:199], v[48:51], v[144:159]
    s_waitcnt lgkmcnt(10)
    ds_read_b64_tr_b16 v[188:189], v229 offset:6144
    ds_read_b64_tr_b16 v[190:191], v229 offset:6656
    s_waitcnt vmcnt(3)
    v_mfma_f32_32x32x16_bf16 v[128:143], v[200:203], v[52:55], v[128:143]
    ds_read_b64_tr_b16 v[192:193], v228 offset:32768
    ds_read_b64_tr_b16 v[194:195], v228 offset:33280
    v_mfma_f32_32x32x16_bf16 v[144:159], v[204:207], v[52:55], v[144:159]
    s_waitcnt lgkmcnt(10)
    ds_read_b64_tr_b16 v[196:197], v229 offset:32768
    ds_read_b64_tr_b16 v[198:199], v229 offset:33280
    s_waitcnt vmcnt(2)
    v_mfma_f32_32x32x16_bf16 v[128:143], v[208:211], v[56:59], v[128:143]
    ds_read_b64_tr_b16 v[200:201], v228 offset:34816
    ds_read_b64_tr_b16 v[202:203], v228 offset:35328
    v_mfma_f32_32x32x16_bf16 v[144:159], v[212:215], v[56:59], v[144:159]
    s_waitcnt lgkmcnt(10)
    ds_read_b64_tr_b16 v[204:205], v229 offset:34816
    ds_read_b64_tr_b16 v[206:207], v229 offset:35328
    s_waitcnt vmcnt(1)
    v_mfma_f32_32x32x16_bf16 v[128:143], v[216:219], v[60:63], v[128:143]
    ds_read_b64_tr_b16 v[208:209], v228 offset:36864
    ds_read_b64_tr_b16 v[210:211], v228 offset:37376
    v_mfma_f32_32x32x16_bf16 v[144:159], v[220:223], v[60:63], v[144:159]
    s_waitcnt lgkmcnt(10)
    ds_read_b64_tr_b16 v[212:213], v229 offset:36864
    ds_read_b64_tr_b16 v[214:215], v229 offset:37376
    s_waitcnt vmcnt(0)
L_chk2:
    v_cmp_ne_u32 vcc, s44, v235
    s_cbranch_vccnz L_spin2
L_ok2:
    buffer_load_dword v235, v234, s[40:43], s45 offen offset:96 sc1
    buffer_load_dwordx4 v[64:67], v232, s[40:43], s14 offen offset:0 sc1
    buffer_load_dwordx4 v[68:71], v232, s[40:43], s14 offen offset:1024 sc1
    buffer_load_dwordx4 v[72:75], v232, s[40:43], s14 offen offset:2048 sc1
    buffer_load_dwordx4 v[76:79], v232, s[40:43], s14 offen offset:3072 sc1
    buffer_load_dwordx4 v[80:83], v233, s[40:43], s14 offen offset:0 sc1
    buffer_load_dwordx4 v[84:87], v233, s[40:43], s14 offen offset:1024 sc1
    buffer_load_dwordx4 v[88:91], v233, s[40:43], s14 offen offset:2048 sc1
    buffer_load_dwordx4 v[92:95], v233, s[40:43], s14 offen offset:3072 sc1
    s_branch L_join1
L_alt2:
    s_waitcnt vmcnt(7)
    v_mfma_f32_32x32x16_bf16 v[128:143], v[160:163], v[64:67], v[128:143]
    ds_read_b64_tr_b16 v[216:217], v228 offset:38912
    ds_read_b64_tr_b16 v[218:219], v228 offset:39424
    v_mfma_f32_32x32x16_bf16 v[144:159], v[164:167], v[64:67], v[144:159]
    s_waitcnt lgkmcnt(10)
    ds_read_b64_tr_b16 v[220:221], v229 offset:38912
    ds_read_b64_tr_b16 v[222:223], v229 offset:39424
    s_waitcnt vmcnt(6)
    v_mfma_f32_32x32x16_bf16 v[128:143], v[168:171], v[68:71], v[128:143]
    ds_read_b64_tr_b16 v[160:161], v230 offset:0
    ds_read_b64_tr_b16 v[162:163], v230 offset:512
    v_mfma_f32_32x32x16_bf16 v[144:159], v[172:175], v[68:71], v[144:159]
    s_waitcnt lgkmcnt(10)
    ds_read_b64_tr_b16 v[164:165], v231 offset:0
    ds_read_b64_tr_b16 v[166:167], v231 offset:512
    s_waitcnt vmcnt(5)
    v_mfma_f32_32x32x16_bf16 v[128:143], v[176:179], v[72:75], v[128:143]
    buffer_load_dword v235, v234, s[40:43], s45 offen offset:96 sc1
    ds_read_b64_tr_b16 v[168:169], v230 offset:2048
    ds_read_b64_tr_b16 v[170:171], v230 offset:2560
    v_mfma_f32_32x32x16_bf16 v[144:159], v[180:183], v[72:75], v[144:159]
    s_waitcnt lgkmcnt(10)
    ds_read_b64_tr_b16 v[172:173], v231 offset:2048
    ds_read_b64_tr_b16 v[174:175], v231 offset:2560
    s_waitcnt vmcnt(5)
    v_mfma_f32_32x32x16_bf16 v[128:143], v[184:187], v[76:79], v[128:143]
    ds_read_b64_tr_b16 v[176:177], v230 offset:4096
    ds_read_b64_tr_b16 v[178:179], v230 offset:4608
    v_mfma_f32_32x32x16_bf16 v[144:159], v[188:191], v[76:79], v[144:159]
    s_waitcnt lgkmcnt(10)
    ds_read_b64_tr_b16 v[180:181], v231 offset:4096
    ds_read_b64_tr_b16 v[182:183], v231 offset:4608
    s_waitcnt vmcnt(4)
    v_mfma_f32_32x32x16_bf16 v[128:143], v[192:195], v[80:83], v[128:143]
    ds_read_b64_tr_b16 v[184:185], v230 offset:6144
    ds_read_b64_tr_b16 v[186:187], v230 offset:6656
    v_mfma_f32_32x32x16_bf16 v[144:159], v[196:199], v[80:83], v[144:159]
    s_waitcnt lgkmcnt(10)
    ds_read_b64_tr_b16 v[188:189], v231 offset:6144
    ds_read_b64_tr_b16 v[190:191], v231 offset:6656
    s_waitcnt vmcnt(3)
    v_mfma_f32_32x32x16_bf16 v[128:143], v[200:203], v[84:87], v[128:143]
    ds_read_b64_tr_b16 v[192:193], v230 offset:32768
    ds_read_b64_tr_b16 v[194:195], v230 offset:33280
    v_mfma_f32_32x32x16_bf16 v[144:159], v[204:207], v[84:87], v[144:159]
    s_waitcnt lgkmcnt(10)
    ds_read_b64_tr_b16 v[196:197], v231 offset:32768
    ds_read_b64_tr_b16 v[198:199], v231 offset:33280
    s_waitcnt vmcnt(2)
    v_mfma_f32_32x32x16_bf16 v[128:143], v[208:211], v[88:91], v[128:143]
    ds_read_b64_tr_b16 v[200:201], v230 offset:34816
    ds_read_b64_tr_b16 v[202:203], v230 offset:35328
    v_mfma_f32_32x32x16_bf16 v[144:159], v[212:215], v[88:91], v[144:159]
    s_waitcnt lgkmcnt(10)
    ds_read_b64_tr_b16 v[204:205], v231 offset:34816
    ds_read_b64_tr_b16 v[206:207], v231 offset:35328
    s_waitcnt vmcnt(1)
    v_mfma_f32_32x32x16_bf16 v[128:143], v[216:219], v[92:95], v[128:143]
    ds_read_b64_tr_b16 v[208:209], v230 offset:36864
    ds_read_b64_tr_b16 v[210:211], v230 offset:37376
    v_mfma_f32_32x32x16_bf16 v[144:159], v[220:223], v[92:95], v[144:159]
    s_waitcnt lgkmcnt(10)
    ds_read_b64_tr_b16 v[212:213], v231 offset:36864
    ds_read_b64_tr_b16 v[214:215], v231 offset:37376
    s_waitcnt vmcnt(0)
L_chk3:
    v_cmp_ne_u32 vcc, s44, v235
    s_cbranch_vccnz L_spin3
L_ok3:
    buffer_load_dwordx4 v[96:99], v232, s[40:43], s15 offen offset:0 sc1
    buffer_load_dwordx4 v[100:103], v232, s[40:43], s15 offen offset:1024 sc1
    buffer_load_dwordx4 v[104:107], v232, s[40:43], s15 offen offset:2048 sc1
    buffer_load_dwordx4 v[108:111], v232, s[40:43], s15 offen offset:3072 sc1
    buffer_load_dwordx4 v[112:115], v233, s[40:43], s15 offen offset:0 sc1
    buffer_load_dwordx4 v[116:119], v233, s[40:43], s15 offen offset:1024 sc1
    buffer_load_dwordx4 v[120:123], v233, s[40:43], s15 offen offset:2048 sc1
    buffer_load_dwordx4 v[124:127], v233, s[40:43], s15 offen offset:3072 sc1
    s_branch L_join2
L_pre:
    buffer_load_dword v235, v234, s[40:43], s45 offen offset:0 sc1
L_lsb:
    ds_read_b128 v[160:163], v242 offset:16
    s_sub_u32 s47, s47, 1
    s_cmp_lt_i32 s47, 0
    s_cbranch_scc1 L_lsxb
    s_waitcnt lgkmcnt(0)
    v_and_b32 v160, v160, v161
    v_and_b32 v162, v162, v163
    v_and_b32 v160, v160, v162
    v_cmp_eq_u32 vcc, 0, v160
    s_cbranch_vccnz L_lsb
L_lsxb:
    ds_read_b64_tr_b16 v[160:161], v224 offset:0
    ds_read_b64_tr_b16 v[162:163], v224 offset:512
    ds_read_b64_tr_b16 v[164:165], v225 offset:0
    ds_read_b64_tr_b16 v[166:167], v225 offset:512
    ds_read_b64_tr_b16 v[168:169], v224 offset:2048
    ds_read_b64_tr_b16 v[170:171], v224 offset:2560
    ds_read_b64_tr_b16 v[172:173], v225 offset:2048
    ds_read_b64_tr_b16 v[174:175], v225 offset:2560
    ds_read_b64_tr_b16 v[176:177], v224 offset:4096
    ds_read_b64_tr_b16 v[178:179], v224 offset:4608
    ds_read_b64_tr_b16 v[180:181], v225 offset:4096
    ds_read_b64_tr_b16 v[182:183], v225 offset:4608
    ds_read_b64_tr_b16 v[184:185], v224 offset:6144
    ds_read_b64_tr_b16 v[186:187], v224 offset:6656
    s_waitcnt lgkmcnt(10)
    ds_read_b64_tr_b16 v[188:189], v225 offset:6144
    ds_read_b64_tr_b16 v[190:191], v225 offset:6656
    ds_read_b64_tr_b16 v[192:193], v224 offset:32768
    ds_read_b64_tr_b16 v[194:195], v224 offset:33280
    s_waitcnt lgkmcnt(10)
    ds_read_b64_tr_b16 v[196:197], v225 offset:32768
    ds_read_b64_tr_b16 v[198:199], v225 offset:33280
    ds_read_b64_tr_b16 v[200:201], v224 offset:34816
    ds_read_b64_tr_b16 v[202:203], v224 offset:35328
    s_waitcnt lgkmcnt(10)
    ds_read_b64_tr_b16 v[204:205], v225 offset:34816
    ds_read_b64_tr_b16 v[206:207], v225 offset:35328
    ds_read_b64_tr_b16 v[208:209], v224 offset:36864
    ds_read_b64_tr_b16 v[210:211], v224 offset:37376
    s_waitcnt lgkmcnt(10)
    ds_read_b64_tr_b16 v[212:213], v225 offset:36864
    ds_read_b64_tr_b16 v[214:215], v225 offset:37376
    s_waitcnt vmcnt(0)
L_chk0:
    v_cmp_ne_u32 vcc, s44, v235
    s_cbranch_vccnz L_spin0
L_ok0:
    buffer_load_dword v235, v234, s[40:43], s45 offen offset:32 sc1
    buffer_load_dwordx4 v[0:3], v232, s[40:43], s12 offen offset:0 sc1
    buffer_load_dwordx4 v[4:7], v232, s[40:43], s12 offen offset:1024 sc1
    buffer_load_dwordx4 v[8:11], v232, s[40:43], s12 offen offset:2048 sc1
    buffer_load_dwordx4 v[12:15], v232, s[40:43], s12 offen offset:3072 sc1
    buffer_load_dwordx4 v[16:19], v233, s[40:43], s12 offen offset:0 sc1
    buffer_load_dwordx4 v[20:23], v233, s[40:43], s12 offen offset:1024 sc1
    buffer_load_dwordx4 v[24:27], v233, s[40:43], s12 offen offset:2048 sc1
    buffer_load_dwordx4 v[28:31], v233, s[40:43], s12 offen offset:3072 sc1
    s_branch L_prej
L_epoch:
    s_lshl_b32 s61, s49, 7
    s_add_u32 s61, s61, 8454144
    v_mov_b32 v242, s44
    s_mov_b64 exec, 1
    buffer_store_dword v242, off, s[40:43], s61
    s_mov_b64 exec, -1
    s_branch L_epochx
L_compute:
    v_and_b32 v1, 15, v0
    v_lshrrev_b32 v2, 4, v0
    v_bfe_u32 v3, v0, 1, 3
    v_xor_b32 v3, v3, v2
    v_lshlrev_b32 v3, 4, v3
    v_lshl_add_u32 v3, v1, 7, v3
    v_add_u32 v224, 8192, v3
    v_xor_b32 v225, 64, v224
    v_add_u32 v226, 40960, v224
    v_add_u32 v227, 40960, v225
    v_add_u32 v228, 81920, v224
    v_add_u32 v229, 81920, v225
    v_and_b32 v3, 6, v0
    v_xor_b32 v3, v3, v2
    v_lshlrev_b32 v3, 4, v3
    v_and_b32 v4, 7, v0
    v_lshl_add_u32 v233, v4, 7, v3
    v_and_b32 v4, 8, v0
    v_xor_b32 v4, 8, v4
    v_lshl_add_u32 v233, v4, 15, v233
    v_xor_b32 v234, 64, v233
    v_bfe_u32 v3, v0, 3, 2
    v_xor_b32 v3, s48, v3
    v_lshlrev_b32 v3, 5, v3
    v_and_b32 v4, 3, v0
    v_lshl_add_u32 v3, v4, 3, v3
    v_bfe_u32 v4, v0, 2, 2
    v_lshl_add_u32 v3, v4, 7, v3
    v_mul_u32_u24 v4, 3072, v2
    v_add_u32 v3, v3, v4
    v_add_u32 v230, 24576, v3
    v_add_u32 v231, 65536, v3
    v_add_u32 v232, 106496, v3
    v_lshlrev_b32 v3, 2, v2
    v_sub_u32 v3, v1, v3
    v_mov_b32 v5, 0xff800000
    s_cmp_eq_u32 s53, 0
    s_cselect_b32 s55, 3480120104, 0
    v_mov_b32 v6, s55
    v_subrev_u32 v4, 0, v3
    v_cmp_gt_i32 s[62:63], 0, v4
    v_and_b32 v4, 8, v4
    v_cmp_eq_u32 vcc, 0, v4
    s_nop 1
    v_cndmask_b32 v216, 0, v6, s[62:63]
    v_cndmask_b32 v212, v5, 0, vcc
    v_cndmask_b32 v216, v5, v216, vcc
    v_mov_b32 v220, 0x3f803f80
    v_subrev_u32 v4, 1, v3
    v_cmp_gt_i32 s[62:63], 0, v4
    v_and_b32 v4, 8, v4
    v_cmp_eq_u32 vcc, 0, v4
    s_nop 1
    v_cndmask_b32 v217, 0, v6, s[62:63]
    v_cndmask_b32 v213, v5, 0, vcc
    v_cndmask_b32 v217, v5, v217, vcc
    v_mov_b32 v221, 0x3f803f80
    v_subrev_u32 v4, 2, v3
    v_cmp_gt_i32 s[62:63], 0, v4
    v_and_b32 v4, 8, v4
    v_cmp_eq_u32 vcc, 0, v4
    s_nop 1
    v_cndmask_b32 v218, 0, v6, s[62:63]
    v_cndmask_b32 v214, v5, 0, vcc
    v_cndmask_b32 v218, v5, v218, vcc
    v_mov_b32 v222, 0x3f803f80
    v_subrev_u32 v4, 3, v3
    v_cmp_gt_i32 s[62:63], 0, v4
    v_and_b32 v4, 8, v4
    v_cmp_eq_u32 vcc, 0, v4
    s_nop 1
    v_cndmask_b32 v219, 0, v6, s[62:63]
    v_cndmask_b32 v215, v5, 0, vcc
    v_cndmask_b32 v219, v5, v219, vcc
    v_mov_b32 v223, 0x3f803f80
    v_lshlrev_b32 v235, 4, v0
    v_mov_b32 v240, 0
    v_mov_b32 v242, -1
    v_mov_b32 v243, -1
    v_mov_b32 v244, -1
    v_mov_b32 v245, -1
    v_lshlrev_b32 v1, 6, v1
    v_lshl_add_u32 v241, v2, 15, v1
    v_min_u32 v236, 1, v0
    v_lshlrev_b32 v236, 30, v236
    s_mov_b32 s56, 1052289595
    s_mov_b32 s58, 0xff00ff00
    s_mov_b32 s59, 0xff00ff00
    s_mov_b32 s60, 0
    s_mov_b32 s61, 0x00ff00ff
    s_and_b32 s46, s50, 3
    s_lshl_b32 s55, s49, 7
    s_add_u32 s47, s55, 8454144
    s_waitcnt lgkmcnt(0)
    s_load_dword s44, s[20:21], s47
    s_mov_b32 s40, s20
    s_mov_b32 s41, s21
    s_mov_b32 s42, 0x10000000
    s_mov_b32 s43, 0x20000
    s_lshl_b32 s47, s50, 2
    s_add_u32 s62, s47, s55
    s_add_u32 s62, s62, 8519680
    s_add_u32 s47, s47, s48
    s_add_u32 s47, s47, s55
    s_lshl_b32 s12, s47, 10
    s_add_u32 s13, s12, 32768
    s_add_u32 s14, s12, 65536
    s_add_u32 s15, s12, 98304
    s_lshl_b32 s45, s49, 7
    s_and_b32 s47, s50, 4
    s_add_u32 s45, s45, s47
    s_add_u32 s45, s45, s48
    s_lshl_b32 s45, s45, 2
    s_add_u32 s45, s45, 8388608
    s_getreg_b32 s63, hwreg(HW_REG_XCC_ID, 0, 4)
    s_waitcnt vmcnt(0) lgkmcnt(0)
    s_add_u32 s63, s63, s44
    s_add_u32 s63, s63, 1374496523
    s_add_u32 s44, s44, 2654435769
    v_mov_b32 v1, s63
    v_mov_b32 v237, s44
    s_cmp_eq_u32 s48, 0
    s_cbranch_scc0 L_noann
    buffer_store_dword v1, v236, s[40:43], s62 offen sc1
L_noann:
    s_cmp_eq_u32 s46, 1
    s_cbranch_scc1 L_w1
    s_cmp_eq_u32 s46, 2
    s_cbranch_scc1 L_w2
    s_cmp_eq_u32 s46, 3
    s_cbranch_scc1 L_w3
    s_branch L_w0
L_wback:
    s_barrier
    ds_read_b64_tr_b16 v[144:145], v230 offset:1024
    ds_read_b64_tr_b16 v[146:147], v230 offset:1536
    ds_read_b64_tr_b16 v[148:149], v230 offset:2048
    ds_read_b64_tr_b16 v[150:151], v230 offset:2560
    ds_read_b64_tr_b16 v[140:141], v230 offset:0
    ds_read_b64_tr_b16 v[142:143], v230 offset:512
    ds_read_b128 v[104:107], v233 offset:0
    ds_read_b128 v[108:111], v224 offset:0
    ds_read_b128 v[112:115], v224 offset:2048
    ds_read_b128 v[116:119], v224 offset:4096
    ds_read_b128 v[120:123], v224 offset:6144
    ds_read_b128 v[124:127], v224 offset:8192
    ds_read_b128 v[128:131], v224 offset:10240
    ds_read_b128 v[132:135], v224 offset:12288
    ds_read_b128 v[136:139], v224 offset:14336
    s_waitcnt lgkmcnt(0)
    v_mfma_f32_16x16x32_bf16 v[32:35], v[144:147], v[104:107], 0
    ds_read_b64_tr_b16 v[192:193], v230 offset:13312
    v_mfma_f32_16x16x32_bf16 v[36:39], v[144:147], v[108:111], 0
    ds_read_b64_tr_b16 v[194:195], v230 offset:13824
    v_mfma_f32_16x16x32_bf16 v[0:3], v[140:143], v[108:111], 0
    ds_read_b64_tr_b16 v[196:197], v230 offset:14336
    v_mfma_f32_16x16x32_bf16 v[4:7], v[140:143], v[112:115], 0
    ds_read_b64_tr_b16 v[198:199], v230 offset:14848
    v_mfma_f32_16x16x32_bf16 v[40:43], v[144:147], v[112:115], 0
    ds_read_b64_tr_b16 v[188:189], v230 offset:12288
    v_mfma_f32_16x16x32_bf16 v[44:47], v[144:147], v[116:119], 0
    ds_read_b64_tr_b16 v[190:191], v230 offset:12800
    v_mfma_f32_16x16x32_bf16 v[8:11], v[140:143], v[116:119], 0
    ds_read_b128 v[152:155], v234 offset:0
    v_mfma_f32_16x16x32_bf16 v[12:15], v[140:143], v[120:123], 0
    ds_read_b128 v[156:159], v225 offset:0
    v_mfma_f32_16x16x32_bf16 v[48:51], v[144:147], v[120:123], 0
    ds_read_b128 v[160:163], v225 offset:2048
    v_mfma_f32_16x16x32_bf16 v[52:55], v[144:147], v[124:127], 0
    ds_read_b128 v[164:167], v225 offset:4096
    v_mfma_f32_16x16x32_bf16 v[16:19], v[140:143], v[124:127], 0
    ds_read_b128 v[168:171], v225 offset:6144
    v_mfma_f32_16x16x32_bf16 v[20:23], v[140:143], v[128:131], 0
    ds_read_b128 v[172:175], v225 offset:8192
    v_mfma_f32_16x16x32_bf16 v[56:59], v[144:147], v[128:131], 0
    ds_read_b128 v[176:179], v225 offset:10240
    v_mfma_f32_16x16x32_bf16 v[60:63], v[144:147], v[132:135], 0
    ds_read_b128 v[180:183], v225 offset:12288
    v_mfma_f32_16x16x32_bf16 v[24:27], v[140:143], v[132:135], 0
    ds_read_b128 v[184:187], v225 offset:14336
    v_mfma_f32_16x16x32_bf16 v[28:31], v[140:143], v[136:139], 0
    v_mfma_f32_16x16x32_bf16 v[64:67], v[144:147], v[136:139], 0
    v_mfma_f32_16x16x32_bf16 v[68:71], v[104:107], v[148:151], 0
    v_mfma_f32_16x16x32_bf16 v[72:75], v[108:111], v[148:151], 0
    v_mfma_f32_16x16x32_bf16 v[76:79], v[112:115], v[148:151], 0
    v_mfma_f32_16x16x32_bf16 v[80:83], v[116:119], v[148:151], 0
    v_mfma_f32_16x16x32_bf16 v[84:87], v[120:123], v[148:151], 0
    v_mfma_f32_16x16x32_bf16 v[88:91], v[124:127], v[148:151], 0
    v_mfma_f32_16x16x32_bf16 v[92:95], v[128:131], v[148:151], 0
    v_mfma_f32_16x16x32_bf16 v[96:99], v[132:135], v[148:151], 0
    v_mfma_f32_16x16x32_bf16 v[100:103], v[136:139], v[148:151], 0
    s_waitcnt lgkmcnt(0)
    v_mfma_f32_16x16x32_bf16 v[32:35], v[192:195], v[152:155], v[32:35]
    v_mfma_f32_16x16x32_bf16 v[36:39], v[192:195], v[156:159], v[36:39]
    v_mfma_f32_16x16x32_bf16 v[0:3], v[188:191], v[156:159], v[0:3]
    v_mfma_f32_16x16x32_bf16 v[4:7], v[188:191], v[160:163], v[4:7]
    v_mfma_f32_16x16x32_bf16 v[40:43], v[192:195], v[160:163], v[40:43]
    v_mfma_f32_16x16x32_bf16 v[44:47], v[192:195], v[164:167], v[44:47]
    v_mfma_f32_16x16x32_bf16 v[8:11], v[188:191], v[164:167], v[8:11]
    v_mfma_f32_16x16x32_bf16 v[12:15], v[188:191], v[168:171], v[12:15]
    v_mfma_f32_16x16x32_bf16 v[48:51], v[192:195], v[168:171], v[48:51]
    v_mfma_f32_16x16x32_bf16 v[52:55], v[192:195], v[172:175], v[52:55]
    s_barrier
    v_mfma_f32_16x16x32_bf16 v[16:19], v[188:191], v[172:175], v[16:19]
    ds_read_b64_tr_b16 v[144:145], v231 offset:1024
    ds_read_b64_tr_b16 v[146:147], v231 offset:1536
    v_mfma_f32_16x16x32_bf16 v[20:23], v[188:191], v[176:179], v[20:23]
    ds_read_b64_tr_b16 v[148:149], v231 offset:2048
    ds_read_b64_tr_b16 v[150:151], v231 offset:2560
    v_mfma_f32_16x16x32_bf16 v[56:59], v[192:195], v[176:179], v[56:59]
    ds_read_b64_tr_b16 v[140:141], v231 offset:0
    ds_read_b64_tr_b16 v[142:143], v231 offset:512
    v_mfma_f32_16x16x32_bf16 v[60:63], v[192:195], v[180:183], v[60:63]
    ds_read_b128 v[104:107], v233 offset:1024
    ds_read_b128 v[108:111], v226 offset:0
    v_mfma_f32_16x16x32_bf16 v[24:27], v[188:191], v[180:183], v[24:27]
    ds_read_b128 v[112:115], v226 offset:2048
    ds_read_b128 v[116:119], v226 offset:4096
    v_mfma_f32_16x16x32_bf16 v[28:31], v[188:191], v[184:187], v[28:31]
    ds_read_b128 v[120:123], v226 offset:6144
    ds_read_b128 v[124:127], v226 offset:8192
    v_mfma_f32_16x16x32_bf16 v[64:67], v[192:195], v[184:187], v[64:67]
    ds_read_b128 v[128:131], v226 offset:10240
    ds_read_b128 v[132:135], v226 offset:12288
    v_mfma_f32_16x16x32_bf16 v[68:71], v[152:155], v[196:199], v[68:71]
    ds_read_b128 v[136:139], v226 offset:14336
    v_mfma_f32_16x16x32_bf16 v[72:75], v[156:159], v[196:199], v[72:75]
    v_mfma_f32_16x16x32_bf16 v[76:79], v[160:163], v[196:199], v[76:79]
    v_mfma_f32_16x16x32_bf16 v[80:83], v[164:167], v[196:199], v[80:83]
    v_mfma_f32_16x16x32_bf16 v[84:87], v[168:171], v[196:199], v[84:87]
    v_mfma_f32_16x16x32_bf16 v[88:91], v[172:175], v[196:199], v[88:91]
    v_mfma_f32_16x16x32_bf16 v[92:95], v[176:179], v[196:199], v[92:95]
    v_mfma_f32_16x16x32_bf16 v[96:99], v[180:183], v[196:199], v[96:99]
    v_mfma_f32_16x16x32_bf16 v[100:103], v[184:187], v[196:199], v[100:103]
    s_waitcnt lgkmcnt(0)
    v_mfma_f32_16x16x32_bf16 v[32:35], v[144:147], v[104:107], v[32:35]
    ds_read_b64_tr_b16 v[192:193], v231 offset:13312
    v_mfma_f32_16x16x32_bf16 v[36:39], v[144:147], v[108:111], v[36:39]
    ds_read_b64_tr_b16 v[194:195], v231 offset:13824
    v_mfma_f32_16x16x32_bf16 v[0:3], v[140:143], v[108:111], v[0:3]
    ds_read_b64_tr_b16 v[196:197], v231 offset:14336
    v_mfma_f32_16x16x32_bf16 v[4:7], v[140:143], v[112:115], v[4:7]
    ds_read_b64_tr_b16 v[198:199], v231 offset:14848
    v_mfma_f32_16x16x32_bf16 v[40:43], v[144:147], v[112:115], v[40:43]
    ds_read_b64_tr_b16 v[188:189], v231 offset:12288
    v_mfma_f32_16x16x32_bf16 v[44:47], v[144:147], v[116:119], v[44:47]
    ds_read_b64_tr_b16 v[190:191], v231 offset:12800
    v_mfma_f32_16x16x32_bf16 v[8:11], v[140:143], v[116:119], v[8:11]
    ds_read_b128 v[152:155], v234 offset:1024
    v_mfma_f32_16x16x32_bf16 v[12:15], v[140:143], v[120:123], v[12:15]
    ds_read_b128 v[156:159], v227 offset:0
    v_mfma_f32_16x16x32_bf16 v[48:51], v[144:147], v[120:123], v[48:51]
    ds_read_b128 v[160:163], v227 offset:2048
    v_mfma_f32_16x16x32_bf16 v[52:55], v[144:147], v[124:127], v[52:55]
    ds_read_b128 v[164:167], v227 offset:4096
    v_mfma_f32_16x16x32_bf16 v[16:19], v[140:143], v[124:127], v[16:19]
    ds_read_b128 v[168:171], v227 offset:6144
    v_mfma_f32_16x16x32_bf16 v[20:23], v[140:143], v[128:131], v[20:23]
    ds_read_b128 v[172:175], v227 offset:8192
    v_mfma_f32_16x16x32_bf16 v[56:59], v[144:147], v[128:131], v[56:59]
    ds_read_b128 v[176:179], v227 offset:10240
    v_mfma_f32_16x16x32_bf16 v[60:63], v[144:147], v[132:135], v[60:63]
    ds_read_b128 v[180:183], v227 offset:12288
    v_mfma_f32_16x16x32_bf16 v[24:27], v[140:143], v[132:135], v[24:27]
    ds_read_b128 v[184:187], v227 offset:14336
    v_mfma_f32_16x16x32_bf16 v[28:31], v[140:143], v[136:139], v[28:31]
    v_mfma_f32_16x16x32_bf16 v[64:67], v[144:147], v[136:139], v[64:67]
    v_mfma_f32_16x16x32_bf16 v[68:71], v[104:107], v[148:151], v[68:71]
    v_mfma_f32_16x16x32_bf16 v[72:75], v[108:111], v[148:151], v[72:75]
    v_mfma_f32_16x16x32_bf16 v[76:79], v[112:115], v[148:151], v[76:79]
    v_mfma_f32_16x16x32_bf16 v[80:83], v[116:119], v[148:151], v[80:83]
    v_mfma_f32_16x16x32_bf16 v[84:87], v[120:123], v[148:151], v[84:87]
    v_mfma_f32_16x16x32_bf16 v[88:91], v[124:127], v[148:151], v[88:91]
    v_mfma_f32_16x16x32_bf16 v[92:95], v[128:131], v[148:151], v[92:95]
    v_mfma_f32_16x16x32_bf16 v[96:99], v[132:135], v[148:151], v[96:99]
    v_mfma_f32_16x16x32_bf16 v[100:103], v[136:139], v[148:151], v[100:103]
    s_waitcnt lgkmcnt(0)
    v_mfma_f32_16x16x32_bf16 v[32:35], v[192:195], v[152:155], v[32:35]
    v_mfma_f32_16x16x32_bf16 v[36:39], v[192:195], v[156:159], v[36:39]
    v_mfma_f32_16x16x32_bf16 v[0:3], v[188:191], v[156:159], v[0:3]
    v_mfma_f32_16x16x32_bf16 v[4:7], v[188:191], v[160:163], v[4:7]
    v_mfma_f32_16x16x32_bf16 v[40:43], v[192:195], v[160:163], v[40:43]
    v_mfma_f32_16x16x32_bf16 v[44:47], v[192:195], v[164:167], v[44:47]
    v_mfma_f32_16x16x32_bf16 v[8:11], v[188:191], v[164:167], v[8:11]
    v_mfma_f32_16x16x32_bf16 v[12:15], v[188:191], v[168:171], v[12:15]
    v_mfma_f32_16x16x32_bf16 v[48:51], v[192:195], v[168:171], v[48:51]
    v_mfma_f32_16x16x32_bf16 v[52:55], v[192:195], v[172:175], v[52:55]
    s_barrier
    v_mfma_f32_16x16x32_bf16 v[16:19], v[188:191], v[172:175], v[16:19]
    ds_read_b64_tr_b16 v[144:145], v232 offset:1024
    ds_read_b64_tr_b16 v[146:147], v232 offset:1536
    v_mfma_f32_16x16x32_bf16 v[20:23], v[188:191], v[176:179], v[20:23]
    ds_read_b64_tr_b16 v[148:149], v232 offset:2048
    ds_read_b64_tr_b16 v[150:151], v232 offset:2560
    v_mfma_f32_16x16x32_bf16 v[56:59], v[192:195], v[176:179], v[56:59]
    ds_read_b64_tr_b16 v[140:141], v232 offset:0
    ds_read_b64_tr_b16 v[142:143], v232 offset:512
    v_mfma_f32_16x16x32_bf16 v[60:63], v[192:195], v[180:183], v[60:63]
    ds_read_b128 v[104:107], v233 offset:2048
    ds_read_b128 v[108:111], v228 offset:0
    v_mfma_f32_16x16x32_bf16 v[24:27], v[188:191], v[180:183], v[24:27]
    ds_read_b128 v[112:115], v228 offset:2048
    ds_read_b128 v[116:119], v228 offset:4096
    v_mfma_f32_16x16x32_bf16 v[28:31], v[188:191], v[184:187], v[28:31]
    ds_read_b128 v[120:123], v228 offset:6144
    ds_read_b128 v[124:127], v228 offset:8192
    v_mfma_f32_16x16x32_bf16 v[64:67], v[192:195], v[184:187], v[64:67]
    ds_read_b128 v[128:131], v228 offset:10240
    ds_read_b128 v[132:135], v228 offset:12288
    v_mfma_f32_16x16x32_bf16 v[68:71], v[152:155], v[196:199], v[68:71]
    ds_read_b128 v[136:139], v228 offset:14336
    v_mfma_f32_16x16x32_bf16 v[72:75], v[156:159], v[196:199], v[72:75]
    v_mfma_f32_16x16x32_bf16 v[76:79], v[160:163], v[196:199], v[76:79]
    v_mfma_f32_16x16x32_bf16 v[80:83], v[164:167], v[196:199], v[80:83]
    v_mfma_f32_16x16x32_bf16 v[84:87], v[168:171], v[196:199], v[84:87]
    v_mfma_f32_16x16x32_bf16 v[88:91], v[172:175], v[196:199], v[88:91]
    v_mfma_f32_16x16x32_bf16 v[92:95], v[176:179], v[196:199], v[92:95]
    v_mfma_f32_16x16x32_bf16 v[96:99], v[180:183], v[196:199], v[96:99]
    v_mfma_f32_16x16x32_bf16 v[100:103], v[184:187], v[196:199], v[100:103]
    s_waitcnt lgkmcnt(0)
    v_mfma_f32_16x16x32_bf16 v[32:35], v[144:147], v[104:107], v[32:35]
    ds_read_b64_tr_b16 v[192:193], v232 offset:13312
    v_mfma_f32_16x16x32_bf16 v[36:39], v[144:147], v[108:111], v[36:39]
    ds_read_b64_tr_b16 v[194:195], v232 offset:13824
    v_mfma_f32_16x16x32_bf16 v[0:3], v[140:143], v[108:111], v[0:3]
    ds_read_b64_tr_b16 v[196:197], v232 offset:14336
    v_mfma_f32_16x16x32_bf16 v[4:7], v[140:143], v[112:115], v[4:7]
    ds_read_b64_tr_b16 v[198:199], v232 offset:14848
    v_mfma_f32_16x16x32_bf16 v[40:43], v[144:147], v[112:115], v[40:43]
    ds_read_b64_tr_b16 v[188:189], v232 offset:12288
    v_mfma_f32_16x16x32_bf16 v[44:47], v[144:147], v[116:119], v[44:47]
    ds_read_b64_tr_b16 v[190:191], v232 offset:12800
    v_mfma_f32_16x16x32_bf16 v[8:11], v[140:143], v[116:119], v[8:11]
    ds_read_b128 v[152:155], v234 offset:2048
    v_mfma_f32_16x16x32_bf16 v[12:15], v[140:143], v[120:123], v[12:15]
    ds_read_b128 v[156:159], v229 offset:0
    v_mfma_f32_16x16x32_bf16 v[48:51], v[144:147], v[120:123], v[48:51]
    ds_read_b128 v[160:163], v229 offset:2048
    v_mfma_f32_16x16x32_bf16 v[52:55], v[144:147], v[124:127], v[52:55]
    ds_read_b128 v[164:167], v229 offset:4096
    v_mfma_f32_16x16x32_bf16 v[16:19], v[140:143], v[124:127], v[16:19]
    ds_read_b128 v[168:171], v229 offset:6144
    v_mfma_f32_16x16x32_bf16 v[20:23], v[140:143], v[128:131], v[20:23]
    ds_read_b128 v[172:175], v229 offset:8192
    v_mfma_f32_16x16x32_bf16 v[56:59], v[144:147], v[128:131], v[56:59]
    ds_read_b128 v[176:179], v229 offset:10240
    v_mfma_f32_16x16x32_bf16 v[60:63], v[144:147], v[132:135], v[60:63]
    ds_read_b128 v[180:183], v229 offset:12288
    v_mfma_f32_16x16x32_bf16 v[24:27], v[140:143], v[132:135], v[24:27]
    ds_read_b128 v[184:187], v229 offset:14336
    v_mfma_f32_16x16x32_bf16 v[28:31], v[140:143], v[136:139], v[28:31]
    v_mfma_f32_16x16x32_bf16 v[64:67], v[144:147], v[136:139], v[64:67]
    v_mfma_f32_16x16x32_bf16 v[68:71], v[104:107], v[148:151], v[68:71]
    v_mfma_f32_16x16x32_bf16 v[72:75], v[108:111], v[148:151], v[72:75]
    v_mfma_f32_16x16x32_bf16 v[76:79], v[112:115], v[148:151], v[76:79]
    v_mfma_f32_16x16x32_bf16 v[80:83], v[116:119], v[148:151], v[80:83]
    v_mfma_f32_16x16x32_bf16 v[84:87], v[120:123], v[148:151], v[84:87]
    v_mfma_f32_16x16x32_bf16 v[88:91], v[124:127], v[148:151], v[88:91]
    v_mfma_f32_16x16x32_bf16 v[92:95], v[128:131], v[148:151], v[92:95]
    v_mfma_f32_16x16x32_bf16 v[96:99], v[132:135], v[148:151], v[96:99]
    v_mfma_f32_16x16x32_bf16 v[100:103], v[136:139], v[148:151], v[100:103]
    s_waitcnt lgkmcnt(0)
    v_mfma_f32_16x16x32_bf16 v[32:35], v[192:195], v[152:155], v[32:35]
    v_mfma_f32_16x16x32_bf16 v[36:39], v[192:195], v[156:159], v[36:39]
    v_mfma_f32_16x16x32_bf16 v[0:3], v[188:191], v[156:159], v[0:3]
    v_mfma_f32_16x16x32_bf16 v[4:7], v[188:191], v[160:163], v[4:7]
    v_mfma_f32_16x16x32_bf16 v[40:43], v[192:195], v[160:163], v[40:43]
    v_mfma_f32_16x16x32_bf16 v[44:47], v[192:195], v[164:167], v[44:47]
    v_mfma_f32_16x16x32_bf16 v[8:11], v[188:191], v[164:167], v[8:11]
    v_mfma_f32_16x16x32_bf16 v[12:15], v[188:191], v[168:171], v[12:15]
    v_mfma_f32_16x16x32_bf16 v[48:51], v[192:195], v[168:171], v[48:51]
    v_mfma_f32_16x16x32_bf16 v[52:55], v[192:195], v[172:175], v[52:55]
    s_barrier
    v_mfma_f32_16x16x32_bf16 v[16:19], v[188:191], v[172:175], v[16:19]
    ds_read_b64_tr_b16 v[144:145], v230 offset:1024
    ds_read_b64_tr_b16 v[146:147], v230 offset:1536
    v_mfma_f32_16x16x32_bf16 v[20:23], v[188:191], v[176:179], v[20:23]
    ds_read_b64_tr_b16 v[148:149], v230 offset:2048
    ds_read_b64_tr_b16 v[150:151], v230 offset:2560
    v_mfma_f32_16x16x32_bf16 v[56:59], v[192:195], v[176:179], v[56:59]
    ds_read_b64_tr_b16 v[140:141], v230 offset:0
    ds_read_b64_tr_b16 v[142:143], v230 offset:512
    v_mfma_f32_16x16x32_bf16 v[60:63], v[192:195], v[180:183], v[60:63]
    ds_read_b128 v[104:107], v233 offset:3072
    ds_read_b128 v[108:111], v224 offset:0
    v_mfma_f32_16x16x32_bf16 v[24:27], v[188:191], v[180:183], v[24:27]
    ds_read_b128 v[112:115], v224 offset:2048
    ds_read_b128 v[116:119], v224 offset:4096
    v_mfma_f32_16x16x32_bf16 v[28:31], v[188:191], v[184:187], v[28:31]
    ds_read_b128 v[120:123], v224 offset:6144
    ds_read_b128 v[124:127], v224 offset:8192
    v_mfma_f32_16x16x32_bf16 v[64:67], v[192:195], v[184:187], v[64:67]
    ds_read_b128 v[128:131], v224 offset:10240
    ds_read_b128 v[132:135], v224 offset:12288
    v_mfma_f32_16x16x32_bf16 v[68:71], v[152:155], v[196:199], v[68:71]
    ds_read_b128 v[136:139], v224 offset:14336
    v_mfma_f32_16x16x32_bf16 v[72:75], v[156:159], v[196:199], v[72:75]
    v_mfma_f32_16x16x32_bf16 v[76:79], v[160:163], v[196:199], v[76:79]
    v_mfma_f32_16x16x32_bf16 v[80:83], v[164:167], v[196:199], v[80:83]
    v_mfma_f32_16x16x32_bf16 v[84:87], v[168:171], v[196:199], v[84:87]
    v_mfma_f32_16x16x32_bf16 v[88:91], v[172:175], v[196:199], v[88:91]
    v_mfma_f32_16x16x32_bf16 v[92:95], v[176:179], v[196:199], v[92:95]
    v_mfma_f32_16x16x32_bf16 v[96:99], v[180:183], v[196:199], v[96:99]
    v_mfma_f32_16x16x32_bf16 v[100:103], v[184:187], v[196:199], v[100:103]
    s_waitcnt lgkmcnt(0)
    v_mfma_f32_16x16x32_bf16 v[32:35], v[144:147], v[104:107], v[32:35]
    ds_read_b64_tr_b16 v[192:193], v230 offset:13312
    v_mfma_f32_16x16x32_bf16 v[36:39], v[144:147], v[108:111], v[36:39]
    ds_read_b64_tr_b16 v[194:195], v230 offset:13824
    v_mfma_f32_16x16x32_bf16 v[0:3], v[140:143], v[108:111], v[0:3]
    ds_read_b64_tr_b16 v[196:197], v230 offset:14336
    v_mfma_f32_16x16x32_bf16 v[4:7], v[140:143], v[112:115], v[4:7]
    ds_read_b64_tr_b16 v[198:199], v230 offset:14848
    v_mfma_f32_16x16x32_bf16 v[40:43], v[144:147], v[112:115], v[40:43]
    ds_read_b64_tr_b16 v[188:189], v230 offset:12288
    v_mfma_f32_16x16x32_bf16 v[44:47], v[144:147], v[116:119], v[44:47]
    ds_read_b64_tr_b16 v[190:191], v230 offset:12800
    v_mfma_f32_16x16x32_bf16 v[8:11], v[140:143], v[116:119], v[8:11]
    ds_read_b128 v[152:155], v234 offset:3072
    v_mfma_f32_16x16x32_bf16 v[12:15], v[140:143], v[120:123], v[12:15]
    ds_read_b128 v[156:159], v225 offset:0
    v_mfma_f32_16x16x32_bf16 v[48:51], v[144:147], v[120:123], v[48:51]
    ds_read_b128 v[160:163], v225 offset:2048
    v_mfma_f32_16x16x32_bf16 v[52:55], v[144:147], v[124:127], v[52:55]
    ds_read_b128 v[164:167], v225 offset:4096
    v_mfma_f32_16x16x32_bf16 v[16:19], v[140:143], v[124:127], v[16:19]
    ds_read_b128 v[168:171], v225 offset:6144
    v_mfma_f32_16x16x32_bf16 v[20:23], v[140:143], v[128:131], v[20:23]
    ds_read_b128 v[172:175], v225 offset:8192
    v_mfma_f32_16x16x32_bf16 v[56:59], v[144:147], v[128:131], v[56:59]
    ds_read_b128 v[176:179], v225 offset:10240
    v_mfma_f32_16x16x32_bf16 v[60:63], v[144:147], v[132:135], v[60:63]
    ds_read_b128 v[180:183], v225 offset:12288
    v_mfma_f32_16x16x32_bf16 v[24:27], v[140:143], v[132:135], v[24:27]
    ds_read_b128 v[184:187], v225 offset:14336
    v_mfma_f32_16x16x32_bf16 v[28:31], v[140:143], v[136:139], v[28:31]
    v_mfma_f32_16x16x32_bf16 v[64:67], v[144:147], v[136:139], v[64:67]
    v_mfma_f32_16x16x32_bf16 v[68:71], v[104:107], v[148:151], v[68:71]
    v_mfma_f32_16x16x32_bf16 v[72:75], v[108:111], v[148:151], v[72:75]
    v_mfma_f32_16x16x32_bf16 v[76:79], v[112:115], v[148:151], v[76:79]
    v_mfma_f32_16x16x32_bf16 v[80:83], v[116:119], v[148:151], v[80:83]
    v_mfma_f32_16x16x32_bf16 v[84:87], v[120:123], v[148:151], v[84:87]
    v_mfma_f32_16x16x32_bf16 v[88:91], v[124:127], v[148:151], v[88:91]
    v_mfma_f32_16x16x32_bf16 v[92:95], v[128:131], v[148:151], v[92:95]
    v_mfma_f32_16x16x32_bf16 v[96:99], v[132:135], v[148:151], v[96:99]
    v_mfma_f32_16x16x32_bf16 v[100:103], v[136:139], v[148:151], v[100:103]
    s_waitcnt lgkmcnt(0)
    v_mfma_f32_16x16x32_bf16 v[32:35], v[192:195], v[152:155], v[32:35]
    v_mfma_f32_16x16x32_bf16 v[36:39], v[192:195], v[156:159], v[36:39]
    v_mfma_f32_16x16x32_bf16 v[0:3], v[188:191], v[156:159], v[0:3]
    v_mfma_f32_16x16x32_bf16 v[4:7], v[188:191], v[160:163], v[4:7]
    v_mfma_f32_16x16x32_bf16 v[40:43], v[192:195], v[160:163], v[40:43]
    v_mfma_f32_16x16x32_bf16 v[44:47], v[192:195], v[164:167], v[44:47]
    v_mfma_f32_16x16x32_bf16 v[8:11], v[188:191], v[164:167], v[8:11]
    v_mfma_f32_16x16x32_bf16 v[12:15], v[188:191], v[168:171], v[12:15]
    v_mfma_f32_16x16x32_bf16 v[48:51], v[192:195], v[168:171], v[48:51]
    v_mfma_f32_16x16x32_bf16 v[52:55], v[192:195], v[172:175], v[52:55]
    s_barrier
    v_mfma_f32_16x16x32_bf16 v[16:19], v[188:191], v[172:175], v[16:19]
    ds_read_b64_tr_b16 v[144:145], v231 offset:1024
    ds_read_b64_tr_b16 v[146:147], v231 offset:1536
    v_mfma_f32_16x16x32_bf16 v[20:23], v[188:191], v[176:179], v[20:23]
    ds_read_b64_tr_b16 v[148:149], v231 offset:2048
    ds_read_b64_tr_b16 v[150:151], v231 offset:2560
    v_mfma_f32_16x16x32_bf16 v[56:59], v[192:195], v[176:179], v[56:59]
    ds_read_b64_tr_b16 v[140:141], v231 offset:0
    ds_read_b64_tr_b16 v[142:143], v231 offset:512
    v_mfma_f32_16x16x32_bf16 v[60:63], v[192:195], v[180:183], v[60:63]
    ds_read_b128 v[104:107], v233 offset:4096
    ds_read_b128 v[108:111], v226 offset:0
    v_mfma_f32_16x16x32_bf16 v[24:27], v[188:191], v[180:183], v[24:27]
    ds_read_b128 v[112:115], v226 offset:2048
    ds_read_b128 v[116:119], v226 offset:4096
    v_mfma_f32_16x16x32_bf16 v[28:31], v[188:191], v[184:187], v[28:31]
    ds_read_b128 v[120:123], v226 offset:6144
    ds_read_b128 v[124:127], v226 offset:8192
    v_mfma_f32_16x16x32_bf16 v[64:67], v[192:195], v[184:187], v[64:67]
    ds_read_b128 v[128:131], v226 offset:10240
    ds_read_b128 v[132:135], v226 offset:12288
    v_mfma_f32_16x16x32_bf16 v[68:71], v[152:155], v[196:199], v[68:71]
    ds_read_b128 v[136:139], v226 offset:14336
    v_mfma_f32_16x16x32_bf16 v[72:75], v[156:159], v[196:199], v[72:75]
    v_mfma_f32_16x16x32_bf16 v[76:79], v[160:163], v[196:199], v[76:79]
    v_mfma_f32_16x16x32_bf16 v[80:83], v[164:167], v[196:199], v[80:83]
    v_mfma_f32_16x16x32_bf16 v[84:87], v[168:171], v[196:199], v[84:87]
    v_mfma_f32_16x16x32_bf16 v[88:91], v[172:175], v[196:199], v[88:91]
    v_mfma_f32_16x16x32_bf16 v[92:95], v[176:179], v[196:199], v[92:95]
    v_mfma_f32_16x16x32_bf16 v[96:99], v[180:183], v[196:199], v[96:99]
    v_mfma_f32_16x16x32_bf16 v[100:103], v[184:187], v[196:199], v[100:103]
    s_waitcnt lgkmcnt(0)
    v_mfma_f32_16x16x32_bf16 v[32:35], v[144:147], v[104:107], v[32:35]
    ds_read_b64_tr_b16 v[192:193], v231 offset:13312
    v_mfma_f32_16x16x32_bf16 v[36:39], v[144:147], v[108:111], v[36:39]
    ds_read_b64_tr_b16 v[194:195], v231 offset:13824
    v_mfma_f32_16x16x32_bf16 v[0:3], v[140:143], v[108:111], v[0:3]
    ds_read_b64_tr_b16 v[196:197], v231 offset:14336
    v_mfma_f32_16x16x32_bf16 v[4:7], v[140:143], v[112:115], v[4:7]
    ds_read_b64_tr_b16 v[198:199], v231 offset:14848
    v_mfma_f32_16x16x32_bf16 v[40:43], v[144:147], v[112:115], v[40:43]
    ds_read_b64_tr_b16 v[188:189], v231 offset:12288
    v_mfma_f32_16x16x32_bf16 v[44:47], v[144:147], v[116:119], v[44:47]
    ds_read_b64_tr_b16 v[190:191], v231 offset:12800
    v_mfma_f32_16x16x32_bf16 v[8:11], v[140:143], v[116:119], v[8:11]
    ds_read_b128 v[152:155], v234 offset:4096
    v_mfma_f32_16x16x32_bf16 v[12:15], v[140:143], v[120:123], v[12:15]
    ds_read_b128 v[156:159], v227 offset:0
    v_mfma_f32_16x16x32_bf16 v[48:51], v[144:147], v[120:123], v[48:51]
    ds_read_b128 v[160:163], v227 offset:2048
    v_mfma_f32_16x16x32_bf16 v[52:55], v[144:147], v[124:127], v[52:55]
    ds_read_b128 v[164:167], v227 offset:4096
    v_mfma_f32_16x16x32_bf16 v[16:19], v[140:143], v[124:127], v[16:19]
    ds_read_b128 v[168:171], v227 offset:6144
    v_mfma_f32_16x16x32_bf16 v[20:23], v[140:143], v[128:131], v[20:23]
    ds_read_b128 v[172:175], v227 offset:8192
    v_mfma_f32_16x16x32_bf16 v[56:59], v[144:147], v[128:131], v[56:59]
    ds_read_b128 v[176:179], v227 offset:10240
    v_mfma_f32_16x16x32_bf16 v[60:63], v[144:147], v[132:135], v[60:63]
    ds_read_b128 v[180:183], v227 offset:12288
    v_mfma_f32_16x16x32_bf16 v[24:27], v[140:143], v[132:135], v[24:27]
    ds_read_b128 v[184:187], v227 offset:14336
    v_mfma_f32_16x16x32_bf16 v[28:31], v[140:143], v[136:139], v[28:31]
    v_mfma_f32_16x16x32_bf16 v[64:67], v[144:147], v[136:139], v[64:67]
    v_mfma_f32_16x16x32_bf16 v[68:71], v[104:107], v[148:151], v[68:71]
    v_mfma_f32_16x16x32_bf16 v[72:75], v[108:111], v[148:151], v[72:75]
    v_mfma_f32_16x16x32_bf16 v[76:79], v[112:115], v[148:151], v[76:79]
    v_mfma_f32_16x16x32_bf16 v[80:83], v[116:119], v[148:151], v[80:83]
    v_mfma_f32_16x16x32_bf16 v[84:87], v[120:123], v[148:151], v[84:87]
    v_mfma_f32_16x16x32_bf16 v[88:91], v[124:127], v[148:151], v[88:91]
    v_mfma_f32_16x16x32_bf16 v[92:95], v[128:131], v[148:151], v[92:95]
    v_mfma_f32_16x16x32_bf16 v[96:99], v[132:135], v[148:151], v[96:99]
    v_mfma_f32_16x16x32_bf16 v[100:103], v[136:139], v[148:151], v[100:103]
    s_waitcnt lgkmcnt(0)
    v_mfma_f32_16x16x32_bf16 v[32:35], v[192:195], v[152:155], v[32:35]
    v_mfma_f32_16x16x32_bf16 v[36:39], v[192:195], v[156:159], v[36:39]
    v_mfma_f32_16x16x32_bf16 v[0:3], v[188:191], v[156:159], v[0:3]
    v_mfma_f32_16x16x32_bf16 v[4:7], v[188:191], v[160:163], v[4:7]
    v_mfma_f32_16x16x32_bf16 v[40:43], v[192:195], v[160:163], v[40:43]
    v_mfma_f32_16x16x32_bf16 v[44:47], v[192:195], v[164:167], v[44:47]
    v_mfma_f32_16x16x32_bf16 v[8:11], v[188:191], v[164:167], v[8:11]
    v_mfma_f32_16x16x32_bf16 v[12:15], v[188:191], v[168:171], v[12:15]
    v_mfma_f32_16x16x32_bf16 v[48:51], v[192:195], v[168:171], v[48:51]
    v_mfma_f32_16x16x32_bf16 v[52:55], v[192:195], v[172:175], v[52:55]
    s_barrier
    v_mfma_f32_16x16x32_bf16 v[16:19], v[188:191], v[172:175], v[16:19]
    ds_read_b64_tr_b16 v[144:145], v232 offset:1024
    ds_read_b64_tr_b16 v[146:147], v232 offset:1536
    v_mfma_f32_16x16x32_bf16 v[20:23], v[188:191], v[176:179], v[20:23]
    ds_read_b64_tr_b16 v[148:149], v232 offset:2048
    ds_read_b64_tr_b16 v[150:151], v232 offset:2560
    v_mfma_f32_16x16x32_bf16 v[56:59], v[192:195], v[176:179], v[56:59]
    ds_read_b64_tr_b16 v[140:141], v232 offset:0
    ds_read_b64_tr_b16 v[142:143], v232 offset:512
    v_mfma_f32_16x16x32_bf16 v[60:63], v[192:195], v[180:183], v[60:63]
    ds_read_b128 v[104:107], v233 offset:5120
    ds_read_b128 v[108:111], v228 offset:0
    v_mfma_f32_16x16x32_bf16 v[24:27], v[188:191], v[180:183], v[24:27]
    ds_read_b128 v[112:115], v228 offset:2048
    ds_read_b128 v[116:119], v228 offset:4096
    v_mfma_f32_16x16x32_bf16 v[28:31], v[188:191], v[184:187], v[28:31]
    ds_read_b128 v[120:123], v228 offset:6144
    ds_read_b128 v[124:127], v228 offset:8192
    v_mfma_f32_16x16x32_bf16 v[64:67], v[192:195], v[184:187], v[64:67]
    ds_read_b128 v[128:131], v228 offset:10240
    ds_read_b128 v[132:135], v228 offset:12288
    v_mfma_f32_16x16x32_bf16 v[68:71], v[152:155], v[196:199], v[68:71]
    ds_read_b128 v[136:139], v228 offset:14336
    v_mfma_f32_16x16x32_bf16 v[72:75], v[156:159], v[196:199], v[72:75]
    v_mfma_f32_16x16x32_bf16 v[76:79], v[160:163], v[196:199], v[76:79]
    v_mfma_f32_16x16x32_bf16 v[80:83], v[164:167], v[196:199], v[80:83]
    v_mfma_f32_16x16x32_bf16 v[84:87], v[168:171], v[196:199], v[84:87]
    v_mfma_f32_16x16x32_bf16 v[88:91], v[172:175], v[196:199], v[88:91]
    v_mfma_f32_16x16x32_bf16 v[92:95], v[176:179], v[196:199], v[92:95]
    v_mfma_f32_16x16x32_bf16 v[96:99], v[180:183], v[196:199], v[96:99]
    v_mfma_f32_16x16x32_bf16 v[100:103], v[184:187], v[196:199], v[100:103]
    s_waitcnt lgkmcnt(0)
    v_mfma_f32_16x16x32_bf16 v[32:35], v[144:147], v[104:107], v[32:35]
    ds_read_b64_tr_b16 v[192:193], v232 offset:13312
    v_mfma_f32_16x16x32_bf16 v[36:39], v[144:147], v[108:111], v[36:39]
    ds_read_b64_tr_b16 v[194:195], v232 offset:13824
    v_mfma_f32_16x16x32_bf16 v[0:3], v[140:143], v[108:111], v[0:3]
    ds_read_b64_tr_b16 v[196:197], v232 offset:14336
    v_mfma_f32_16x16x32_bf16 v[4:7], v[140:143], v[112:115], v[4:7]
    ds_read_b64_tr_b16 v[198:199], v232 offset:14848
    v_mfma_f32_16x16x32_bf16 v[40:43], v[144:147], v[112:115], v[40:43]
    ds_read_b64_tr_b16 v[188:189], v232 offset:12288
    v_mfma_f32_16x16x32_bf16 v[44:47], v[144:147], v[116:119], v[44:47]
    ds_read_b64_tr_b16 v[190:191], v232 offset:12800
    v_mfma_f32_16x16x32_bf16 v[8:11], v[140:143], v[116:119], v[8:11]
    ds_read_b128 v[152:155], v234 offset:5120
    v_mfma_f32_16x16x32_bf16 v[12:15], v[140:143], v[120:123], v[12:15]
    ds_read_b128 v[156:159], v229 offset:0
    v_mfma_f32_16x16x32_bf16 v[48:51], v[144:147], v[120:123], v[48:51]
    ds_read_b128 v[160:163], v229 offset:2048
    v_mfma_f32_16x16x32_bf16 v[52:55], v[144:147], v[124:127], v[52:55]
    ds_read_b128 v[164:167], v229 offset:4096
    v_mfma_f32_16x16x32_bf16 v[16:19], v[140:143], v[124:127], v[16:19]
    ds_read_b128 v[168:171], v229 offset:6144
    v_mfma_f32_16x16x32_bf16 v[20:23], v[140:143], v[128:131], v[20:23]
    ds_read_b128 v[172:175], v229 offset:8192
    v_mfma_f32_16x16x32_bf16 v[56:59], v[144:147], v[128:131], v[56:59]
    ds_read_b128 v[176:179], v229 offset:10240
    v_mfma_f32_16x16x32_bf16 v[60:63], v[144:147], v[132:135], v[60:63]
    ds_read_b128 v[180:183], v229 offset:12288
    v_mfma_f32_16x16x32_bf16 v[24:27], v[140:143], v[132:135], v[24:27]
    ds_read_b128 v[184:187], v229 offset:14336
    v_mfma_f32_16x16x32_bf16 v[28:31], v[140:143], v[136:139], v[28:31]
    v_mfma_f32_16x16x32_bf16 v[64:67], v[144:147], v[136:139], v[64:67]
    v_mfma_f32_16x16x32_bf16 v[68:71], v[104:107], v[148:151], v[68:71]
    v_mfma_f32_16x16x32_bf16 v[72:75], v[108:111], v[148:151], v[72:75]
    v_mfma_f32_16x16x32_bf16 v[76:79], v[112:115], v[148:151], v[76:79]
    v_mfma_f32_16x16x32_bf16 v[80:83], v[116:119], v[148:151], v[80:83]
    v_mfma_f32_16x16x32_bf16 v[84:87], v[120:123], v[148:151], v[84:87]
    v_mfma_f32_16x16x32_bf16 v[88:91], v[124:127], v[148:151], v[88:91]
    v_mfma_f32_16x16x32_bf16 v[92:95], v[128:131], v[148:151], v[92:95]
    v_mfma_f32_16x16x32_bf16 v[96:99], v[132:135], v[148:151], v[96:99]
    v_mfma_f32_16x16x32_bf16 v[100:103], v[136:139], v[148:151], v[100:103]
    s_waitcnt lgkmcnt(0)
    v_mfma_f32_16x16x32_bf16 v[32:35], v[192:195], v[152:155], v[32:35]
    v_mfma_f32_16x16x32_bf16 v[36:39], v[192:195], v[156:159], v[36:39]
    v_mfma_f32_16x16x32_bf16 v[0:3], v[188:191], v[156:159], v[0:3]
    v_mfma_f32_16x16x32_bf16 v[4:7], v[188:191], v[160:163], v[4:7]
    v_mfma_f32_16x16x32_bf16 v[40:43], v[192:195], v[160:163], v[40:43]
    v_mfma_f32_16x16x32_bf16 v[44:47], v[192:195], v[164:167], v[44:47]
    v_mfma_f32_16x16x32_bf16 v[8:11], v[188:191], v[164:167], v[8:11]
    v_mfma_f32_16x16x32_bf16 v[12:15], v[188:191], v[168:171], v[12:15]
    v_mfma_f32_16x16x32_bf16 v[48:51], v[192:195], v[168:171], v[48:51]
    v_mfma_f32_16x16x32_bf16 v[52:55], v[192:195], v[172:175], v[52:55]
    s_barrier
    v_mfma_f32_16x16x32_bf16 v[16:19], v[188:191], v[172:175], v[16:19]
    ds_read_b64_tr_b16 v[144:145], v230 offset:1024
    ds_read_b64_tr_b16 v[146:147], v230 offset:1536
    v_mfma_f32_16x16x32_bf16 v[20:23], v[188:191], v[176:179], v[20:23]
    ds_read_b64_tr_b16 v[148:149], v230 offset:2048
    ds_read_b64_tr_b16 v[150:151], v230 offset:2560
    v_mfma_f32_16x16x32_bf16 v[56:59], v[192:195], v[176:179], v[56:59]
    ds_read_b64_tr_b16 v[140:141], v230 offset:0
    ds_read_b64_tr_b16 v[142:143], v230 offset:512
    v_mfma_f32_16x16x32_bf16 v[60:63], v[192:195], v[180:183], v[60:63]
    ds_read_b128 v[104:107], v233 offset:6144
    ds_read_b128 v[108:111], v224 offset:0
    v_mfma_f32_16x16x32_bf16 v[24:27], v[188:191], v[180:183], v[24:27]
    ds_read_b128 v[112:115], v224 offset:2048
    ds_read_b128 v[116:119], v224 offset:4096
    v_mfma_f32_16x16x32_bf16 v[28:31], v[188:191], v[184:187], v[28:31]
    ds_read_b128 v[120:123], v224 offset:6144
    ds_read_b128 v[124:127], v224 offset:8192
    v_mfma_f32_16x16x32_bf16 v[64:67], v[192:195], v[184:187], v[64:67]
    ds_read_b128 v[128:131], v224 offset:10240
    ds_read_b128 v[132:135], v224 offset:12288
    v_mfma_f32_16x16x32_bf16 v[68:71], v[152:155], v[196:199], v[68:71]
    ds_read_b128 v[136:139], v224 offset:14336
    v_mfma_f32_16x16x32_bf16 v[72:75], v[156:159], v[196:199], v[72:75]
    v_mfma_f32_16x16x32_bf16 v[76:79], v[160:163], v[196:199], v[76:79]
    v_mfma_f32_16x16x32_bf16 v[80:83], v[164:167], v[196:199], v[80:83]
    v_mfma_f32_16x16x32_bf16 v[84:87], v[168:171], v[196:199], v[84:87]
    v_mfma_f32_16x16x32_bf16 v[88:91], v[172:175], v[196:199], v[88:91]
    v_mfma_f32_16x16x32_bf16 v[92:95], v[176:179], v[196:199], v[92:95]
    v_mfma_f32_16x16x32_bf16 v[96:99], v[180:183], v[196:199], v[96:99]
    v_mfma_f32_16x16x32_bf16 v[100:103], v[184:187], v[196:199], v[100:103]
    s_waitcnt lgkmcnt(0)
    v_mfma_f32_16x16x32_bf16 v[32:35], v[144:147], v[104:107], v[32:35]
    ds_read_b64_tr_b16 v[192:193], v230 offset:13312
    v_mfma_f32_16x16x32_bf16 v[36:39], v[144:147], v[108:111], v[36:39]
    ds_read_b64_tr_b16 v[194:195], v230 offset:13824
    v_mfma_f32_16x16x32_bf16 v[0:3], v[140:143], v[108:111], v[0:3]
    ds_read_b64_tr_b16 v[196:197], v230 offset:14336
    v_mfma_f32_16x16x32_bf16 v[4:7], v[140:143], v[112:115], v[4:7]
    ds_read_b64_tr_b16 v[198:199], v230 offset:14848
    v_mfma_f32_16x16x32_bf16 v[40:43], v[144:147], v[112:115], v[40:43]
    ds_read_b64_tr_b16 v[188:189], v230 offset:12288
    v_mfma_f32_16x16x32_bf16 v[44:47], v[144:147], v[116:119], v[44:47]
    ds_read_b64_tr_b16 v[190:191], v230 offset:12800
    v_mfma_f32_16x16x32_bf16 v[8:11], v[140:143], v[116:119], v[8:11]
    ds_read_b128 v[152:155], v234 offset:6144
    v_mfma_f32_16x16x32_bf16 v[12:15], v[140:143], v[120:123], v[12:15]
    ds_read_b128 v[156:159], v225 offset:0
    v_mfma_f32_16x16x32_bf16 v[48:51], v[144:147], v[120:123], v[48:51]
    ds_read_b128 v[160:163], v225 offset:2048
    v_mfma_f32_16x16x32_bf16 v[52:55], v[144:147], v[124:127], v[52:55]
    ds_read_b128 v[164:167], v225 offset:4096
    v_mfma_f32_16x16x32_bf16 v[16:19], v[140:143], v[124:127], v[16:19]
    ds_read_b128 v[168:171], v225 offset:6144
    v_mfma_f32_16x16x32_bf16 v[20:23], v[140:143], v[128:131], v[20:23]
    ds_read_b128 v[172:175], v225 offset:8192
    v_mfma_f32_16x16x32_bf16 v[56:59], v[144:147], v[128:131], v[56:59]
    ds_read_b128 v[176:179], v225 offset:10240
    v_mfma_f32_16x16x32_bf16 v[60:63], v[144:147], v[132:135], v[60:63]
    ds_read_b128 v[180:183], v225 offset:12288
    v_mfma_f32_16x16x32_bf16 v[24:27], v[140:143], v[132:135], v[24:27]
    ds_read_b128 v[184:187], v225 offset:14336
    v_mfma_f32_16x16x32_bf16 v[28:31], v[140:143], v[136:139], v[28:31]
    v_mfma_f32_16x16x32_bf16 v[64:67], v[144:147], v[136:139], v[64:67]
    v_mfma_f32_16x16x32_bf16 v[68:71], v[104:107], v[148:151], v[68:71]
    v_mfma_f32_16x16x32_bf16 v[72:75], v[108:111], v[148:151], v[72:75]
    v_mfma_f32_16x16x32_bf16 v[76:79], v[112:115], v[148:151], v[76:79]
    v_mfma_f32_16x16x32_bf16 v[80:83], v[116:119], v[148:151], v[80:83]
    v_mfma_f32_16x16x32_bf16 v[84:87], v[120:123], v[148:151], v[84:87]
    v_mfma_f32_16x16x32_bf16 v[88:91], v[124:127], v[148:151], v[88:91]
    v_mfma_f32_16x16x32_bf16 v[92:95], v[128:131], v[148:151], v[92:95]
    v_mfma_f32_16x16x32_bf16 v[96:99], v[132:135], v[148:151], v[96:99]
    v_mfma_f32_16x16x32_bf16 v[100:103], v[136:139], v[148:151], v[100:103]
    s_cmp_eq_u32 s46, 1
    s_cbranch_scc1 L_v1
    s_cmp_eq_u32 s46, 2
    s_cbranch_scc1 L_v2
    s_cmp_eq_u32 s46, 3
    s_cbranch_scc1 L_v3
    s_branch L_v0
    .p2align 12
L_w0:
    s_branch L_wback
    s_nop 0
L_v0:
    s_waitcnt lgkmcnt(0)
    s_barrier
    s_setprio 3
    v_mfma_f32_16x16x32_bf16 v[32:35], v[192:195], v[152:155], v[32:35]
    v_mov_b32 v224, 0
    ds_read_b64_tr_b16 v[144:145], v231 offset:1024
    v_mfma_f32_16x16x32_bf16 v[68:71], v[152:155], v[196:199], v[68:71]
    ds_read_b64_tr_b16 v[146:147], v231 offset:1536
    ds_read_b64_tr_b16 v[148:149], v231 offset:2048
    v_mfma_f32_16x16x32_bf16 v[36:39], v[192:195], v[156:159], v[36:39]
    ds_read_b64_tr_b16 v[150:151], v231 offset:2560
    ds_read_b64_tr_b16 v[140:141], v231 offset:0
    v_mfma_f32_16x16x32_bf16 v[0:3], v[188:191], v[156:159], v[0:3]
    ds_read_b64_tr_b16 v[142:143], v231 offset:512
    ds_read_b64_tr_b16 v[204:205], v231 offset:13312
    v_mfma_f32_16x16x32_bf16 v[72:75], v[156:159], v[196:199], v[72:75]
    ds_read_b64_tr_b16 v[206:207], v231 offset:13824
    ds_read_b64_tr_b16 v[208:209], v231 offset:14336
    v_mfma_f32_16x16x32_bf16 v[40:43], v[192:195], v[160:163], v[40:43]
    ds_read_b64_tr_b16 v[210:211], v231 offset:14848
    ds_read_b64_tr_b16 v[200:201], v231 offset:12288
    v_mfma_f32_16x16x32_bf16 v[4:7], v[188:191], v[160:163], v[4:7]
    ds_read_b64_tr_b16 v[202:203], v231 offset:12800
    ds_read_b128 v[104:107], v233 offset:7168
    v_mfma_f32_16x16x32_bf16 v[76:79], v[160:163], v[196:199], v[76:79]
    ds_read_b128 v[152:155], v234 offset:7168
    s_waitcnt lgkmcnt(9)
    ds_read_b128 v[108:111], v226 offset:0
    v_mfma_f32_16x16x32_bf16 v[44:47], v[192:195], v[164:167], v[44:47]
    ds_read_b128 v[156:159], v227 offset:0
    ds_read_b128 v[112:115], v226 offset:2048
    v_mfma_f32_16x16x32_bf16 v[8:11], v[188:191], v[164:167], v[8:11]
    ds_read_b128 v[160:163], v227 offset:2048
    ds_read_b128 v[116:119], v226 offset:4096
    v_mfma_f32_16x16x32_bf16 v[80:83], v[164:167], v[196:199], v[80:83]
    s_waitcnt lgkmcnt(9)
    ds_read_b128 v[120:123], v226 offset:6144
    ds_read_b128 v[124:127], v226 offset:8192
    v_mfma_f32_16x16x32_bf16 v[48:51], v[192:195], v[168:171], v[48:51]
    ds_read_b128 v[164:167], v227 offset:4096
    ds_read_b128 v[128:131], v226 offset:10240
    v_mfma_f32_16x16x32_bf16 v[12:15], v[188:191], v[168:171], v[12:15]
    ds_read_b128 v[132:135], v226 offset:12288
    s_waitcnt lgkmcnt(9)
    ds_read_b128 v[136:139], v226 offset:14336
    v_mfma_f32_16x16x32_bf16 v[84:87], v[168:171], v[196:199], v[84:87]
    ds_read_b32 v225, v224
    v_mfma_f32_16x16x32_bf16 v[52:55], v[192:195], v[172:175], v[52:55]
    ds_read_b128 v[168:171], v227 offset:6144
    v_mfma_f32_16x16x32_bf16 v[32:35], v[144:147], v[104:107], v[32:35]
    v_mfma_f32_16x16x32_bf16 v[68:71], v[104:107], v[148:151], v[68:71]
    v_mfma_f32_16x16x32_bf16 v[32:35], v[204:207], v[152:155], v[32:35]
    v_mfma_f32_16x16x32_bf16 v[68:71], v[152:155], v[208:211], v[68:71]
    v_mfma_f32_16x16x32_bf16 v[36:39], v[144:147], v[108:111], v[36:39]
    v_mfma_f32_16x16x32_bf16 v[0:3], v[140:143], v[108:111], v[0:3]
    v_mfma_f32_16x16x32_bf16 v[72:75], v[108:111], v[148:151], v[72:75]
    s_waitcnt lgkmcnt(1)
    v_cmp_ne_u32 vcc, 0, v225
    v_mfma_f32_16x16x32_bf16 v[36:39], v[204:207], v[156:159], v[36:39]
    v_mfma_f32_16x16x32_bf16 v[0:3], v[200:203], v[156:159], v[0:3]
    v_cvt_pk_bf16_f32 v32, v32, v33
    v_mfma_f32_16x16x32_bf16 v[72:75], v[156:159], v[208:211], v[72:75]
    v_cvt_pk_bf16_f32 v33, v34, v35
    v_cvt_pk_bf16_f32 v254, v68, v69
    v_mfma_f32_16x16x32_bf16 v[40:43], v[144:147], v[112:115], v[40:43]
    v_cvt_pk_bf16_f32 v255, v70, v71
    s_nop 0
    v_cvt_pk_bf16_f32 v36, v36, v37
    v_mfma_f32_16x16x32_bf16 v[4:7], v[140:143], v[112:115], v[4:7]
    v_cvt_pk_bf16_f32 v37, v38, v39
    v_cndmask_b32 v38, v36, v32, s[58:59]
    v_mfma_f32_16x16x32_bf16 v[76:79], v[112:115], v[148:151], v[76:79]
    v_cvt_pk_bf16_f32 v252, v72, v73
    v_cvt_pk_bf16_f32 v253, v74, v75
    v_mfma_f32_16x16x32_bf16 v[40:43], v[204:207], v[160:163], v[40:43]
    v_cndmask_b32 v39, v37, v33, s[58:59]
    v_cvt_pk_bf16_f32 v0, v0, v1
    v_mfma_f32_16x16x32_bf16 v[4:7], v[200:203], v[160:163], v[4:7]
    v_cvt_pk_bf16_f32 v1, v2, v3
    v_cndmask_b32 v2, v0, 0, s[58:59]
    v_mfma_f32_16x16x32_bf16 v[76:79], v[160:163], v[208:211], v[76:79]
    v_cndmask_b32 v3, v1, 0, s[58:59]
    v_cndmask_b32 v0, 0, v0, s[58:59]
    v_mfma_f32_16x16x32_bf16 v[44:47], v[144:147], v[116:119], v[44:47]
    v_cvt_pk_bf16_f32 v40, v40, v41
    v_cvt_pk_bf16_f32 v41, v42, v43
    v_mfma_f32_16x16x32_bf16 v[8:11], v[140:143], v[116:119], v[8:11]
    v_cndmask_b32 v1, 0, v1, s[58:59]
    v_cndmask_b32 v42, v40, v36, s[58:59]
    v_mfma_f32_16x16x32_bf16 v[80:83], v[116:119], v[148:151], v[80:83]
    v_cvt_pk_bf16_f32 v250, v76, v77
    v_cvt_pk_bf16_f32 v251, v78, v79
    v_mfma_f32_16x16x32_bf16 v[108:111], v[36:39], v[0:3], v[216:219]
    v_cndmask_b32 v43, v41, v37, s[58:59]
    v_cvt_pk_bf16_f32 v4, v4, v5
    v_mfma_f32_16x16x32_bf16 v[44:47], v[204:207], v[164:167], v[44:47]
    v_cvt_pk_bf16_f32 v5, v6, v7
    v_cndmask_b32 v6, v4, 0, s[58:59]
    v_mfma_f32_16x16x32_bf16 v[8:11], v[200:203], v[164:167], v[8:11]
    v_cndmask_b32 v7, v5, 0, s[58:59]
    v_cndmask_b32 v4, 0, v4, s[58:59]
    v_mfma_f32_16x16x32_bf16 v[80:83], v[164:167], v[208:211], v[80:83]
    v_cndmask_b32 v5, 0, v5, s[58:59]
    v_max3_f32 v156, v108, v109, v110
    v_mfma_f32_16x16x32_bf16 v[48:51], v[144:147], v[120:123], v[48:51]
    v_max_f32 v156, v156, v111
    v_cvt_pk_bf16_f32 v44, v44, v45
    v_mfma_f32_16x16x32_bf16 v[112:115], v[40:43], v[4:7], v[212:215]
    v_cvt_pk_bf16_f32 v45, v46, v47
    v_cndmask_b32 v46, v44, v40, s[58:59]
    v_mfma_f32_16x16x32_bf16 v[12:15], v[140:143], v[120:123], v[12:15]
    v_cvt_pk_bf16_f32 v248, v80, v81
    v_cvt_pk_bf16_f32 v249, v82, v83
    v_mfma_f32_16x16x32_bf16 v[84:87], v[120:123], v[148:151], v[84:87]
    v_cndmask_b32 v47, v45, v41, s[58:59]
    v_cvt_pk_bf16_f32 v8, v8, v9
    s_waitcnt lgkmcnt(0)
    v_mfma_f32_16x16x32_bf16 v[48:51], v[204:207], v[168:171], v[48:51]
    v_max3_f32 v160, v112, v113, v114
    v_max_f32 v160, v160, v115
    v_mfma_f32_16x16x32_bf16 v[12:15], v[200:203], v[168:171], v[12:15]
    v_cvt_pk_bf16_f32 v9, v10, v11
    v_permlane32_swap_b32 v156, v160
    v_mfma_f32_16x16x32_bf16 v[84:87], v[168:171], v[208:211], v[84:87]
    v_max_f32 v157, v156, v160
    v_max_f32 v156, v156, v160
    v_mfma_f32_16x16x32_bf16 v[16:19], v[188:191], v[172:175], v[16:19]
    v_cvt_pk_bf16_f32 v48, v48, v49
    v_permlane16_swap_b32 v156, v157
    v_mfma_f32_16x16x32_bf16 v[88:91], v[172:175], v[196:199], v[88:91]
    v_max_f32 v156, v156, v157
    v_mul_f32 v160, s56, -v156
    v_mfma_f32_16x16x32_bf16 v[52:55], v[144:147], v[124:127], v[52:55]
    ds_read_b128 v[172:175], v227 offset:8192
    v_mul_f32 v156, s56, -v156
    v_mfma_f32_16x16x32_bf16 v[16:19], v[140:143], v[124:127], v[16:19]
    v_cvt_pk_bf16_f32 v49, v50, v51
    v_permlane32_swap_b32 v156, v160
    v_mfma_f32_16x16x32_bf16 v[88:91], v[124:127], v[148:151], v[88:91]
    v_fma_f32 v108, v108, s56, v156
    v_fma_f32 v109, v109, s56, v156
    v_mfma_f32_16x16x32_bf16 v[56:59], v[192:195], v[176:179], v[56:59]
    v_fma_f32 v110, v110, s56, v156
    v_fma_f32 v111, v111, s56, v156
    v_mfma_f32_16x16x32_bf16 v[20:23], v[188:191], v[176:179], v[20:23]
    v_exp_f32 v108, v108
    v_mfma_f32_16x16x32_bf16 v[92:95], v[176:179], v[196:199], v[92:95]
    v_exp_f32 v109, v109
    v_mfma_f32_16x16x32_bf16 v[56:59], v[144:147], v[128:131], v[56:59]
    ds_read_b128 v[176:179], v227 offset:10240
    v_exp_f32 v110, v110
    v_mfma_f32_16x16x32_bf16 v[20:23], v[140:143], v[128:131], v[20:23]
    v_exp_f32 v111, v111
    v_mfma_f32_16x16x32_bf16 v[92:95], v[128:131], v[148:151], v[92:95]
    v_cvt_pk_bf16_f32 v0, v108, v109
    v_cvt_pk_bf16_f32 v1, v110, v111
    s_waitcnt lgkmcnt(1)
    v_mfma_f32_16x16x32_bf16 v[52:55], v[204:207], v[172:175], v[52:55]
    v_cndmask_b32 v2, 0, v0, s[60:61]
    v_cndmask_b32 v3, 0, v1, s[60:61]
    v_mfma_f32_16x16x32_bf16 v[16:19], v[200:203], v[172:175], v[16:19]
    v_cndmask_b32 v0, v0, 0, s[60:61]
    v_cndmask_b32 v1, v1, 0, s[60:61]
    v_mfma_f32_16x16x32_bf16 v[88:91], v[172:175], v[208:211], v[88:91]
    v_fma_f32 v112, v112, s56, v160
    v_fma_f32 v113, v113, s56, v160
    v_mfma_f32_16x16x32_bf16 v[156:159], v[220:223], v[0:3], 0
    v_fma_f32 v114, v114, s56, v160
    v_fma_f32 v115, v115, s56, v160
    v_mfma_f32_16x16x32_bf16 v[72:75], v[252:255], v[0:3], 0
    v_exp_f32 v112, v112
    v_mfma_f32_16x16x32_bf16 v[60:63], v[192:195], v[180:183], v[60:63]
    v_exp_f32 v113, v113
    s_waitcnt lgkmcnt(0)
    v_mfma_f32_16x16x32_bf16 v[56:59], v[204:207], v[176:179], v[56:59]
    v_exp_f32 v114, v114
    v_mfma_f32_16x16x32_bf16 v[20:23], v[200:203], v[176:179], v[20:23]
    v_exp_f32 v115, v115
    v_mfma_f32_16x16x32_bf16 v[92:95], v[176:179], v[208:211], v[92:95]
    v_cvt_pk_bf16_f32 v4, v112, v113
    v_cvt_pk_bf16_f32 v5, v114, v115
    v_mfma_f32_16x16x32_bf16 v[24:27], v[188:191], v[180:183], v[24:27]
    v_cndmask_b32 v6, 0, v4, s[60:61]
    v_cndmask_b32 v7, 0, v5, s[60:61]
    v_mfma_f32_16x16x32_bf16 v[96:99], v[180:183], v[196:199], v[96:99]
    v_cndmask_b32 v4, v4, 0, s[60:61]
    v_cndmask_b32 v5, v5, 0, s[60:61]
    v_mfma_f32_16x16x32_bf16 v[60:63], v[144:147], v[132:135], v[60:63]
    ds_read_b128 v[180:183], v227 offset:12288
    v_rcp_f32 v156, v156
    v_mfma_f32_16x16x32_bf16 v[160:163], v[220:223], v[4:7], 0
    v_mul_f32 v72, v72, v156
    v_mul_f32 v73, v73, v156
    v_mfma_f32_16x16x32_bf16 v[76:79], v[250:253], v[4:7], 0
    v_mul_f32 v74, v74, v156
    v_mul_f32 v75, v75, v156
    v_mfma_f32_16x16x32_bf16 v[24:27], v[140:143], v[132:135], v[24:27]
    v_cvt_pk_bf16_f32 v108, v72, v73
    v_cvt_pk_bf16_f32 v109, v74, v75
    v_mfma_f32_16x16x32_bf16 v[96:99], v[132:135], v[148:151], v[96:99]
    v_rcp_f32 v160, v160
    v_mfma_f32_16x16x32_bf16 v[64:67], v[192:195], v[184:187], v[64:67]
    v_mul_f32 v76, v76, v160
    v_mul_f32 v77, v77, v160
    v_mfma_f32_16x16x32_bf16 v[28:31], v[188:191], v[184:187], v[28:31]
    v_mul_f32 v78, v78, v160
    v_mul_f32 v79, v79, v160
    v_mfma_f32_16x16x32_bf16 v[100:103], v[184:187], v[196:199], v[100:103]
    v_cvt_pk_bf16_f32 v110, v76, v77
    v_cvt_pk_bf16_f32 v111, v78, v79
    v_mfma_f32_16x16x32_bf16 v[64:67], v[144:147], v[136:139], v[64:67]
    ds_read_b128 v[184:187], v227 offset:14336
    v_permlane16_swap_b32 v108, v110
    s_waitcnt lgkmcnt(1)
    v_mfma_f32_16x16x32_bf16 v[60:63], v[204:207], v[180:183], v[60:63]
    v_permlane16_swap_b32 v109, v111
    buffer_store_dwordx4 v[108:111], v235, s[40:43], s12 offen sc1
    v_mfma_f32_16x16x32_bf16 v[24:27], v[200:203], v[180:183], v[24:27]
    v_cvt_pk_bf16_f32 v246, v84, v85
    v_cvt_pk_bf16_f32 v247, v86, v87
    v_mfma_f32_16x16x32_bf16 v[96:99], v[180:183], v[208:211], v[96:99]
    v_cndmask_b32 v10, v8, 0, s[58:59]
    v_cndmask_b32 v11, v9, 0, s[58:59]
    v_mfma_f32_16x16x32_bf16 v[28:31], v[140:143], v[136:139], v[28:31]
    v_cndmask_b32 v8, 0, v8, s[58:59]
    v_cndmask_b32 v9, 0, v9, s[58:59]
    v_mfma_f32_16x16x32_bf16 v[100:103], v[136:139], v[148:151], v[100:103]
    v_cndmask_b32 v50, v48, v44, s[58:59]
    v_cndmask_b32 v51, v49, v45, s[58:59]
    v_mfma_f32_16x16x32_bf16 v[116:119], v[44:47], v[8:11], v[212:215]
    v_cvt_pk_bf16_f32 v12, v12, v13
    v_cvt_pk_bf16_f32 v13, v14, v15
    v_cndmask_b32 v14, v12, 0, s[58:59]
    v_cndmask_b32 v15, v13, 0, s[58:59]
    v_cndmask_b32 v12, 0, v12, s[58:59]
    v_cndmask_b32 v13, 0, v13, s[58:59]
    v_cvt_pk_bf16_f32 v52, v52, v53
    v_cvt_pk_bf16_f32 v53, v54, v55
    v_mfma_f32_16x16x32_bf16 v[120:123], v[48:51], v[12:15], v[212:215]
    v_max3_f32 v164, v116, v117, v118
    v_max_f32 v164, v164, v119
    s_waitcnt lgkmcnt(0)
    v_mfma_f32_16x16x32_bf16 v[64:67], v[204:207], v[184:187], v[64:67]
    v_cvt_pk_bf16_f32 v244, v88, v89
    v_cvt_pk_bf16_f32 v245, v90, v91
    v_mfma_f32_16x16x32_bf16 v[28:31], v[200:203], v[184:187], v[28:31]
    v_cvt_pk_bf16_f32 v56, v56, v57
    v_cvt_pk_bf16_f32 v57, v58, v59
    v_mfma_f32_16x16x32_bf16 v[100:103], v[184:187], v[208:211], v[100:103]
    v_max3_f32 v168, v120, v121, v122
    v_max_f32 v168, v168, v123
    v_cvt_pk_bf16_f32 v242, v92, v93
    v_cvt_pk_bf16_f32 v243, v94, v95
    v_permlane32_swap_b32 v164, v168
    v_max_f32 v165, v164, v168
    v_max_f32 v164, v164, v168
    v_cndmask_b32 v54, v52, v48, s[58:59]
    v_cndmask_b32 v55, v53, v49, s[58:59]
    v_permlane16_swap_b32 v164, v165
    v_max_f32 v164, v164, v165
    v_mul_f32 v168, s56, -v164
    v_mul_f32 v164, s56, -v164
    v_cvt_pk_bf16_f32 v16, v16, v17
    v_cvt_pk_bf16_f32 v17, v18, v19
    v_permlane32_swap_b32 v164, v168
    v_fma_f32 v116, v116, s56, v164
    v_fma_f32 v117, v117, s56, v164
    v_fma_f32 v118, v118, s56, v164
    v_fma_f32 v119, v119, s56, v164
    v_exp_f32 v116, v116
    v_exp_f32 v117, v117
    v_exp_f32 v118, v118
    v_exp_f32 v119, v119
    v_cvt_pk_bf16_f32 v8, v116, v117
    v_cvt_pk_bf16_f32 v9, v118, v119
    v_cndmask_b32 v10, 0, v8, s[60:61]
    v_cndmask_b32 v11, 0, v9, s[60:61]
    v_cndmask_b32 v8, v8, 0, s[60:61]
    v_cndmask_b32 v9, v9, 0, s[60:61]
    v_fma_f32 v120, v120, s56, v168
    v_fma_f32 v121, v121, s56, v168
    v_mfma_f32_16x16x32_bf16 v[164:167], v[220:223], v[8:11], 0
    v_fma_f32 v122, v122, s56, v168
    v_fma_f32 v123, v123, s56, v168
    v_mfma_f32_16x16x32_bf16 v[80:83], v[248:251], v[8:11], 0
    v_exp_f32 v120, v120
    v_exp_f32 v121, v121
    v_exp_f32 v122, v122
    v_exp_f32 v123, v123
    v_cvt_pk_bf16_f32 v12, v120, v121
    v_cvt_pk_bf16_f32 v13, v122, v123
    v_cndmask_b32 v14, 0, v12, s[60:61]
    v_cndmask_b32 v15, 0, v13, s[60:61]
    v_cndmask_b32 v12, v12, 0, s[60:61]
    v_cndmask_b32 v13, v13, 0, s[60:61]
    v_rcp_f32 v164, v164
    v_cndmask_b32 v18, v16, 0, s[58:59]
    v_mfma_f32_16x16x32_bf16 v[168:171], v[220:223], v[12:15], 0
    v_mul_f32 v80, v80, v164
    v_mul_f32 v81, v81, v164
    v_mfma_f32_16x16x32_bf16 v[84:87], v[246:249], v[12:15], 0
    v_mul_f32 v82, v82, v164
    v_mul_f32 v83, v83, v164
    v_cvt_pk_bf16_f32 v116, v80, v81
    v_cvt_pk_bf16_f32 v117, v82, v83
    v_cndmask_b32 v19, v17, 0, s[58:59]
    v_rcp_f32 v168, v168
    v_cndmask_b32 v16, 0, v16, s[58:59]
    v_cndmask_b32 v17, 0, v17, s[58:59]
    v_mul_f32 v84, v84, v168
    v_mul_f32 v85, v85, v168
    v_mfma_f32_16x16x32_bf16 v[124:127], v[52:55], v[16:19], v[212:215]
    v_mul_f32 v86, v86, v168
    v_mul_f32 v87, v87, v168
    v_cvt_pk_bf16_f32 v118, v84, v85
    v_cvt_pk_bf16_f32 v119, v86, v87
    v_cndmask_b32 v58, v56, v52, s[58:59]
    v_permlane16_swap_b32 v116, v118
    v_permlane16_swap_b32 v117, v119
    buffer_store_dwordx4 v[116:119], v235, s[40:43], s13 offen sc1
    v_cndmask_b32 v59, v57, v53, s[58:59]
    v_cvt_pk_bf16_f32 v20, v20, v21
    v_cvt_pk_bf16_f32 v21, v22, v23
    v_cndmask_b32 v22, v20, 0, s[58:59]
    v_cndmask_b32 v23, v21, 0, s[58:59]
    v_cndmask_b32 v20, 0, v20, s[58:59]
    v_cndmask_b32 v21, 0, v21, s[58:59]
    v_max3_f32 v172, v124, v125, v126
    v_max_f32 v172, v172, v127
    v_mfma_f32_16x16x32_bf16 v[128:131], v[56:59], v[20:23], v[212:215]
    v_cvt_pk_bf16_f32 v60, v60, v61
    v_cvt_pk_bf16_f32 v61, v62, v63
    v_cvt_pk_bf16_f32 v240, v96, v97
    v_cvt_pk_bf16_f32 v241, v98, v99
    v_cvt_pk_bf16_f32 v64, v64, v65
    v_cvt_pk_bf16_f32 v65, v66, v67
    v_cvt_pk_bf16_f32 v238, v100, v101
    v_cvt_pk_bf16_f32 v239, v102, v103
    v_max3_f32 v176, v128, v129, v130
    v_max_f32 v176, v176, v131
    v_cndmask_b32 v62, v60, v56, s[58:59]
    v_cndmask_b32 v63, v61, v57, s[58:59]
    s_waitcnt vmcnt(1)
    s_cbranch_vccz L_fs00
    buffer_store_dword v237, v236, s[40:43], s45 offen offset:0
L_fb00:
    v_permlane32_swap_b32 v172, v176
    v_max_f32 v173, v172, v176
    v_max_f32 v172, v172, v176
    v_cvt_pk_bf16_f32 v24, v24, v25
    v_cvt_pk_bf16_f32 v25, v26, v27
    v_permlane16_swap_b32 v172, v173
    v_max_f32 v172, v172, v173
    v_mul_f32 v176, s56, -v172
    v_mul_f32 v172, s56, -v172
    v_cndmask_b32 v26, v24, 0, s[58:59]
    v_cndmask_b32 v27, v25, 0, s[58:59]
    v_permlane32_swap_b32 v172, v176
    v_fma_f32 v124, v124, s56, v172
    v_fma_f32 v125, v125, s56, v172
    v_fma_f32 v126, v126, s56, v172
    v_fma_f32 v127, v127, s56, v172
    v_exp_f32 v124, v124
    v_exp_f32 v125, v125
    v_exp_f32 v126, v126
    v_exp_f32 v127, v127
    v_cvt_pk_bf16_f32 v16, v124, v125
    v_cvt_pk_bf16_f32 v17, v126, v127
    v_cndmask_b32 v18, 0, v16, s[60:61]
    v_cndmask_b32 v19, 0, v17, s[60:61]
    v_cndmask_b32 v16, v16, 0, s[60:61]
    v_cndmask_b32 v17, v17, 0, s[60:61]
    v_fma_f32 v128, v128, s56, v176
    v_fma_f32 v129, v129, s56, v176
    v_mfma_f32_16x16x32_bf16 v[172:175], v[220:223], v[16:19], 0
    v_fma_f32 v130, v130, s56, v176
    v_fma_f32 v131, v131, s56, v176
    v_mfma_f32_16x16x32_bf16 v[88:91], v[244:247], v[16:19], 0
    v_exp_f32 v128, v128
    v_exp_f32 v129, v129
    v_exp_f32 v130, v130
    v_exp_f32 v131, v131
    v_cvt_pk_bf16_f32 v20, v128, v129
    v_cvt_pk_bf16_f32 v21, v130, v131
    v_cndmask_b32 v22, 0, v20, s[60:61]
    v_cndmask_b32 v23, 0, v21, s[60:61]
    v_cndmask_b32 v20, v20, 0, s[60:61]
    v_cndmask_b32 v21, v21, 0, s[60:61]
    v_rcp_f32 v172, v172
    v_cndmask_b32 v24, 0, v24, s[58:59]
    v_mfma_f32_16x16x32_bf16 v[176:179], v[220:223], v[20:23], 0
    v_mul_f32 v88, v88, v172
    v_mul_f32 v89, v89, v172
    v_mfma_f32_16x16x32_bf16 v[92:95], v[242:245], v[20:23], 0
    v_mul_f32 v90, v90, v172
    v_mul_f32 v91, v91, v172
    v_cvt_pk_bf16_f32 v124, v88, v89
    v_cvt_pk_bf16_f32 v125, v90, v91
    v_cndmask_b32 v25, 0, v25, s[58:59]
    v_rcp_f32 v176, v176
    v_cndmask_b32 v66, v64, v60, s[58:59]
    v_mfma_f32_16x16x32_bf16 v[132:135], v[60:63], v[24:27], v[212:215]
    v_mul_f32 v92, v92, v176
    v_mul_f32 v93, v93, v176
    v_mul_f32 v94, v94, v176
    v_mul_f32 v95, v95, v176
    v_cvt_pk_bf16_f32 v126, v92, v93
    v_cvt_pk_bf16_f32 v127, v94, v95
    v_cndmask_b32 v67, v65, v61, s[58:59]
    v_permlane16_swap_b32 v124, v126
    v_permlane16_swap_b32 v125, v127
    buffer_store_dwordx4 v[124:127], v235, s[40:43], s14 offen sc1
    v_cvt_pk_bf16_f32 v28, v28, v29
    v_cvt_pk_bf16_f32 v29, v30, v31
    v_cndmask_b32 v30, v28, 0, s[58:59]
    v_cndmask_b32 v31, v29, 0, s[58:59]
    v_cndmask_b32 v28, 0, v28, s[58:59]
    v_cndmask_b32 v29, 0, v29, s[58:59]
    v_max3_f32 v180, v132, v133, v134
    v_max_f32 v180, v180, v135
    v_mfma_f32_16x16x32_bf16 v[136:139], v[64:67], v[28:31], v[212:215]
    s_nop 7
    v_max3_f32 v184, v136, v137, v138
    v_max_f32 v184, v184, v139
    s_nop 1
    v_permlane32_swap_b32 v180, v184
    v_max_f32 v181, v180, v184
    v_max_f32 v180, v180, v184
    s_nop 1
    v_permlane16_swap_b32 v180, v181
    v_max_f32 v180, v180, v181
    v_mul_f32 v184, s56, -v180
    v_mul_f32 v180, s56, -v180
    s_nop 1
    v_permlane32_swap_b32 v180, v184
    v_fma_f32 v132, v132, s56, v180
    v_fma_f32 v133, v133, s56, v180
    v_fma_f32 v134, v134, s56, v180
    v_fma_f32 v135, v135, s56, v180
    v_exp_f32 v132, v132
    v_exp_f32 v133, v133
    v_exp_f32 v134, v134
    s_waitcnt vmcnt(2)
    s_cbranch_vccz L_fs01
    buffer_store_dword v237, v236, s[40:43], s45 offen offset:160
L_fb01:
    v_exp_f32 v135, v135
    v_cvt_pk_bf16_f32 v24, v132, v133
    v_cvt_pk_bf16_f32 v25, v134, v135
    v_cndmask_b32 v26, 0, v24, s[60:61]
    v_cndmask_b32 v27, 0, v25, s[60:61]
    v_cndmask_b32 v24, v24, 0, s[60:61]
    v_cndmask_b32 v25, v25, 0, s[60:61]
    v_fma_f32 v136, v136, s56, v184
    v_fma_f32 v137, v137, s56, v184
    v_mfma_f32_16x16x32_bf16 v[180:183], v[220:223], v[24:27], 0
    v_fma_f32 v138, v138, s56, v184
    v_fma_f32 v139, v139, s56, v184
    v_mfma_f32_16x16x32_bf16 v[96:99], v[240:243], v[24:27], 0
    v_exp_f32 v136, v136
    v_exp_f32 v137, v137
    v_exp_f32 v138, v138
    v_exp_f32 v139, v139
    v_cvt_pk_bf16_f32 v28, v136, v137
    v_cvt_pk_bf16_f32 v29, v138, v139
    v_cndmask_b32 v30, 0, v28, s[60:61]
    v_cndmask_b32 v31, 0, v29, s[60:61]
    v_cndmask_b32 v28, v28, 0, s[60:61]
    v_cndmask_b32 v29, v29, 0, s[60:61]
    v_rcp_f32 v180, v180
    s_nop 0
    v_mfma_f32_16x16x32_bf16 v[184:187], v[220:223], v[28:31], 0
    v_mul_f32 v96, v96, v180
    v_mul_f32 v97, v97, v180
    v_mfma_f32_16x16x32_bf16 v[100:103], v[238:241], v[28:31], 0
    v_mul_f32 v98, v98, v180
    v_mul_f32 v99, v99, v180
    v_cvt_pk_bf16_f32 v132, v96, v97
    v_cvt_pk_bf16_f32 v133, v98, v99
    s_nop 0
    v_rcp_f32 v184, v184
    s_nop 1
    v_mul_f32 v100, v100, v184
    v_mul_f32 v101, v101, v184
    v_mul_f32 v102, v102, v184
    v_mul_f32 v103, v103, v184
    v_cvt_pk_bf16_f32 v134, v100, v101
    v_cvt_pk_bf16_f32 v135, v102, v103
    s_nop 0
    v_permlane16_swap_b32 v132, v134
    v_permlane16_swap_b32 v133, v135
    buffer_store_dwordx4 v[132:135], v235, s[40:43], s15 offen sc1
    s_waitcnt vmcnt(2)
    s_cbranch_vccz L_fs02
    buffer_store_dword v237, v236, s[40:43], s45 offen offset:320
L_fb02:
    s_waitcnt vmcnt(1)
    s_cbranch_vccz L_fs03
    buffer_store_dword v237, v236, s[40:43], s45 offen offset:480
L_fb03:
    s_endpgm
L_fs00:
    buffer_store_dword v237, v236, s[40:43], s45 offen offset:0 sc1
    s_branch L_fb00
L_fs01:
    buffer_store_dword v237, v236, s[40:43], s45 offen offset:160 sc1
    s_branch L_fb01
L_fs02:
    buffer_store_dword v237, v236, s[40:43], s45 offen offset:320 sc1
    s_branch L_fb02
L_fs03:
    buffer_store_dword v237, v236, s[40:43], s45 offen offset:480 sc1
    s_branch L_fb03
L_ve0:
.fill (3520-(L_ve0-L_w0))/4, 4, 0xbf800000
    .p2align 12
L_w1:
    s_branch L_wback
    s_nop 0
L_v1:
    s_waitcnt lgkmcnt(0)
    s_barrier
    s_setprio 3
    v_mfma_f32_16x16x32_bf16 v[40:43], v[192:195], v[160:163], v[40:43]
    v_mov_b32 v224, 0
    ds_read_b64_tr_b16 v[144:145], v231 offset:1024
    v_mfma_f32_16x16x32_bf16 v[4:7], v[188:191], v[160:163], v[4:7]
    ds_read_b64_tr_b16 v[146:147], v231 offset:1536
    ds_read_b64_tr_b16 v[148:149], v231 offset:2048
    v_mfma_f32_16x16x32_bf16 v[76:79], v[160:163], v[196:199], v[76:79]
    ds_read_b64_tr_b16 v[150:151], v231 offset:2560
    ds_read_b64_tr_b16 v[140:141], v231 offset:0
    v_mfma_f32_16x16x32_bf16 v[44:47], v[192:195], v[164:167], v[44:47]
    ds_read_b64_tr_b16 v[142:143], v231 offset:512
    ds_read_b64_tr_b16 v[204:205], v231 offset:13312
    v_mfma_f32_16x16x32_bf16 v[8:11], v[188:191], v[164:167], v[8:11]
    ds_read_b64_tr_b16 v[206:207], v231 offset:13824
    ds_read_b64_tr_b16 v[208:209], v231 offset:14336
    v_mfma_f32_16x16x32_bf16 v[80:83], v[164:167], v[196:199], v[80:83]
    ds_read_b64_tr_b16 v[210:211], v231 offset:14848
    ds_read_b64_tr_b16 v[200:201], v231 offset:12288
    v_mfma_f32_16x16x32_bf16 v[48:51], v[192:195], v[168:171], v[48:51]
    ds_read_b64_tr_b16 v[202:203], v231 offset:12800
    ds_read_b128 v[112:115], v226 offset:2048
    v_mfma_f32_16x16x32_bf16 v[12:15], v[188:191], v[168:171], v[12:15]
    ds_read_b128 v[160:163], v227 offset:2048
    s_waitcnt lgkmcnt(9)
    ds_read_b128 v[116:119], v226 offset:4096
    v_mfma_f32_16x16x32_bf16 v[84:87], v[168:171], v[196:199], v[84:87]
    ds_read_b128 v[164:167], v227 offset:4096
    ds_read_b128 v[120:123], v226 offset:6144
    v_mfma_f32_16x16x32_bf16 v[52:55], v[192:195], v[172:175], v[52:55]
    ds_read_b128 v[168:171], v227 offset:6144
    ds_read_b128 v[124:127], v226 offset:8192
    v_mfma_f32_16x16x32_bf16 v[16:19], v[188:191], v[172:175], v[16:19]
    s_waitcnt lgkmcnt(9)
    ds_read_b128 v[128:131], v226 offset:10240
    ds_read_b128 v[132:135], v226 offset:12288
    v_mfma_f32_16x16x32_bf16 v[88:91], v[172:175], v[196:199], v[88:91]
    ds_read_b128 v[136:139], v226 offset:14336
    ds_read_b128 v[104:107], v233 offset:7168
    v_mfma_f32_16x16x32_bf16 v[56:59], v[192:195], v[176:179], v[56:59]
    ds_read_b128 v[172:175], v227 offset:8192
    s_waitcnt lgkmcnt(9)
    ds_read_b128 v[108:111], v226 offset:0
    v_mfma_f32_16x16x32_bf16 v[20:23], v[188:191], v[176:179], v[20:23]
    ds_read_b32 v225, v224
    v_mfma_f32_16x16x32_bf16 v[92:95], v[176:179], v[196:199], v[92:95]
    v_mfma_f32_16x16x32_bf16 v[40:43], v[144:147], v[112:115], v[40:43]
    ds_read_b128 v[176:179], v227 offset:10240
    v_mfma_f32_16x16x32_bf16 v[76:79], v[112:115], v[148:151], v[76:79]
    v_mfma_f32_16x16x32_bf16 v[40:43], v[204:207], v[160:163], v[40:43]
    v_mfma_f32_16x16x32_bf16 v[76:79], v[160:163], v[208:211], v[76:79]
    v_mfma_f32_16x16x32_bf16 v[44:47], v[144:147], v[116:119], v[44:47]
    v_mfma_f32_16x16x32_bf16 v[8:11], v[140:143], v[116:119], v[8:11]
    v_mfma_f32_16x16x32_bf16 v[80:83], v[116:119], v[148:151], v[80:83]
    s_waitcnt lgkmcnt(1)
    v_cmp_ne_u32 vcc, 0, v225
    v_mfma_f32_16x16x32_bf16 v[44:47], v[204:207], v[164:167], v[44:47]
    v_mfma_f32_16x16x32_bf16 v[8:11], v[200:203], v[164:167], v[8:11]
    v_cvt_pk_bf16_f32 v40, v40, v41
    v_mfma_f32_16x16x32_bf16 v[80:83], v[164:167], v[208:211], v[80:83]
    v_cvt_pk_bf16_f32 v41, v42, v43
    v_cvt_pk_bf16_f32 v250, v76, v77
    v_mfma_f32_16x16x32_bf16 v[48:51], v[144:147], v[120:123], v[48:51]
    v_cvt_pk_bf16_f32 v251, v78, v79
    s_nop 0
    v_cvt_pk_bf16_f32 v44, v44, v45
    v_mfma_f32_16x16x32_bf16 v[12:15], v[140:143], v[120:123], v[12:15]
    v_cvt_pk_bf16_f32 v45, v46, v47
    v_cndmask_b32 v46, v44, v40, s[58:59]
    v_mfma_f32_16x16x32_bf16 v[84:87], v[120:123], v[148:151], v[84:87]
    v_cvt_pk_bf16_f32 v248, v80, v81
    v_cvt_pk_bf16_f32 v249, v82, v83
    v_mfma_f32_16x16x32_bf16 v[48:51], v[204:207], v[168:171], v[48:51]
    v_cndmask_b32 v47, v45, v41, s[58:59]
    v_cvt_pk_bf16_f32 v8, v8, v9
    v_mfma_f32_16x16x32_bf16 v[12:15], v[200:203], v[168:171], v[12:15]
    v_cvt_pk_bf16_f32 v9, v10, v11
    v_cndmask_b32 v10, v8, 0, s[58:59]
    v_mfma_f32_16x16x32_bf16 v[84:87], v[168:171], v[208:211], v[84:87]
    v_cndmask_b32 v11, v9, 0, s[58:59]
    v_cndmask_b32 v8, 0, v8, s[58:59]
    v_mfma_f32_16x16x32_bf16 v[52:55], v[144:147], v[124:127], v[52:55]
    v_cvt_pk_bf16_f32 v48, v48, v49
    v_cvt_pk_bf16_f32 v49, v50, v51
    v_mfma_f32_16x16x32_bf16 v[16:19], v[140:143], v[124:127], v[16:19]
    v_cndmask_b32 v9, 0, v9, s[58:59]
    v_cndmask_b32 v50, v48, v44, s[58:59]
    v_mfma_f32_16x16x32_bf16 v[88:91], v[124:127], v[148:151], v[88:91]
    v_cvt_pk_bf16_f32 v246, v84, v85
    v_cvt_pk_bf16_f32 v247, v86, v87
    v_mfma_f32_16x16x32_bf16 v[116:119], v[44:47], v[8:11], v[212:215]
    v_cndmask_b32 v51, v49, v45, s[58:59]
    v_cvt_pk_bf16_f32 v12, v12, v13
    v_mfma_f32_16x16x32_bf16 v[52:55], v[204:207], v[172:175], v[52:55]
    v_cvt_pk_bf16_f32 v13, v14, v15
    v_cndmask_b32 v14, v12, 0, s[58:59]
    v_mfma_f32_16x16x32_bf16 v[16:19], v[200:203], v[172:175], v[16:19]
    v_cndmask_b32 v15, v13, 0, s[58:59]
    v_cndmask_b32 v12, 0, v12, s[58:59]
    v_mfma_f32_16x16x32_bf16 v[88:91], v[172:175], v[208:211], v[88:91]
    v_cndmask_b32 v13, 0, v13, s[58:59]
    v_max3_f32 v164, v116, v117, v118
    v_mfma_f32_16x16x32_bf16 v[56:59], v[144:147], v[128:131], v[56:59]
    v_max_f32 v164, v164, v119
    v_cvt_pk_bf16_f32 v52, v52, v53
    v_mfma_f32_16x16x32_bf16 v[120:123], v[48:51], v[12:15], v[212:215]
    v_cvt_pk_bf16_f32 v53, v54, v55
    v_cndmask_b32 v54, v52, v48, s[58:59]
    v_mfma_f32_16x16x32_bf16 v[20:23], v[140:143], v[128:131], v[20:23]
    v_cvt_pk_bf16_f32 v244, v88, v89
    v_cvt_pk_bf16_f32 v245, v90, v91
    v_mfma_f32_16x16x32_bf16 v[92:95], v[128:131], v[148:151], v[92:95]
    v_cndmask_b32 v55, v53, v49, s[58:59]
    v_cvt_pk_bf16_f32 v16, v16, v17
    s_waitcnt lgkmcnt(0)
    v_mfma_f32_16x16x32_bf16 v[56:59], v[204:207], v[176:179], v[56:59]
    v_max3_f32 v168, v120, v121, v122
    v_max_f32 v168, v168, v123
    v_mfma_f32_16x16x32_bf16 v[20:23], v[200:203], v[176:179], v[20:23]
    v_cvt_pk_bf16_f32 v17, v18, v19
    v_permlane32_swap_b32 v164, v168
    v_mfma_f32_16x16x32_bf16 v[92:95], v[176:179], v[208:211], v[92:95]
    v_max_f32 v165, v164, v168
    v_max_f32 v164, v164, v168
    v_mfma_f32_16x16x32_bf16 v[60:63], v[192:195], v[180:183], v[60:63]
    v_cvt_pk_bf16_f32 v56, v56, v57
    v_permlane16_swap_b32 v164, v165
    v_mfma_f32_16x16x32_bf16 v[24:27], v[188:191], v[180:183], v[24:27]
    v_max_f32 v164, v164, v165
    v_mul_f32 v168, s56, -v164
    v_mfma_f32_16x16x32_bf16 v[96:99], v[180:183], v[196:199], v[96:99]
    v_mul_f32 v164, s56, -v164
    v_cvt_pk_bf16_f32 v57, v58, v59
    v_mfma_f32_16x16x32_bf16 v[60:63], v[144:147], v[132:135], v[60:63]
    ds_read_b128 v[180:183], v227 offset:12288
    v_permlane32_swap_b32 v164, v168
    v_mfma_f32_16x16x32_bf16 v[24:27], v[140:143], v[132:135], v[24:27]
    v_fma_f32 v116, v116, s56, v164
    v_fma_f32 v117, v117, s56, v164
    v_mfma_f32_16x16x32_bf16 v[96:99], v[132:135], v[148:151], v[96:99]
    v_fma_f32 v118, v118, s56, v164
    v_fma_f32 v119, v119, s56, v164
    v_mfma_f32_16x16x32_bf16 v[64:67], v[192:195], v[184:187], v[64:67]
    v_exp_f32 v116, v116
    v_mfma_f32_16x16x32_bf16 v[28:31], v[188:191], v[184:187], v[28:31]
    v_exp_f32 v117, v117
    v_mfma_f32_16x16x32_bf16 v[100:103], v[184:187], v[196:199], v[100:103]
    v_exp_f32 v118, v118
    v_mfma_f32_16x16x32_bf16 v[64:67], v[144:147], v[136:139], v[64:67]
    ds_read_b128 v[184:187], v227 offset:14336
    v_exp_f32 v119, v119
    v_mfma_f32_16x16x32_bf16 v[28:31], v[140:143], v[136:139], v[28:31]
    v_cvt_pk_bf16_f32 v8, v116, v117
    v_cvt_pk_bf16_f32 v9, v118, v119
    v_mfma_f32_16x16x32_bf16 v[100:103], v[136:139], v[148:151], v[100:103]
    v_cndmask_b32 v10, 0, v8, s[60:61]
    v_cndmask_b32 v11, 0, v9, s[60:61]
    s_waitcnt lgkmcnt(1)
    v_mfma_f32_16x16x32_bf16 v[60:63], v[204:207], v[180:183], v[60:63]
    v_cndmask_b32 v8, v8, 0, s[60:61]
    v_cndmask_b32 v9, v9, 0, s[60:61]
    v_mfma_f32_16x16x32_bf16 v[24:27], v[200:203], v[180:183], v[24:27]
    v_fma_f32 v120, v120, s56, v168
    v_fma_f32 v121, v121, s56, v168
    v_mfma_f32_16x16x32_bf16 v[164:167], v[220:223], v[8:11], 0
    v_fma_f32 v122, v122, s56, v168
    v_fma_f32 v123, v123, s56, v168
    v_mfma_f32_16x16x32_bf16 v[80:83], v[248:251], v[8:11], 0
    v_exp_f32 v120, v120
    v_mfma_f32_16x16x32_bf16 v[96:99], v[180:183], v[208:211], v[96:99]
    v_exp_f32 v121, v121
    v_mfma_f32_16x16x32_bf16 v[32:35], v[192:195], v[152:155], v[32:35]
    v_exp_f32 v122, v122
    s_waitcnt lgkmcnt(0)
    v_mfma_f32_16x16x32_bf16 v[64:67], v[204:207], v[184:187], v[64:67]
    v_exp_f32 v123, v123
    v_mfma_f32_16x16x32_bf16 v[28:31], v[200:203], v[184:187], v[28:31]
    v_cvt_pk_bf16_f32 v12, v120, v121
    v_cvt_pk_bf16_f32 v13, v122, v123
    v_mfma_f32_16x16x32_bf16 v[100:103], v[184:187], v[208:211], v[100:103]
    v_cndmask_b32 v14, 0, v12, s[60:61]
    v_cndmask_b32 v15, 0, v13, s[60:61]
    v_mfma_f32_16x16x32_bf16 v[68:71], v[152:155], v[196:199], v[68:71]
    v_cndmask_b32 v12, v12, 0, s[60:61]
    v_cndmask_b32 v13, v13, 0, s[60:61]
    v_mfma_f32_16x16x32_bf16 v[32:35], v[144:147], v[104:107], v[32:35]
    ds_read_b128 v[152:155], v234 offset:7168
    v_rcp_f32 v164, v164
    v_mfma_f32_16x16x32_bf16 v[168:171], v[220:223], v[12:15], 0
    v_mul_f32 v80, v80, v164
    v_mul_f32 v81, v81, v164
    v_mfma_f32_16x16x32_bf16 v[84:87], v[246:249], v[12:15], 0
    v_mul_f32 v82, v82, v164
    v_mul_f32 v83, v83, v164
    v_mfma_f32_16x16x32_bf16 v[68:71], v[104:107], v[148:151], v[68:71]
    v_cvt_pk_bf16_f32 v116, v80, v81
    v_cvt_pk_bf16_f32 v117, v82, v83
    v_mfma_f32_16x16x32_bf16 v[36:39], v[192:195], v[156:159], v[36:39]
    v_rcp_f32 v168, v168
    v_mfma_f32_16x16x32_bf16 v[0:3], v[188:191], v[156:159], v[0:3]
    v_mul_f32 v84, v84, v168
    v_mul_f32 v85, v85, v168
    v_mfma_f32_16x16x32_bf16 v[72:75], v[156:159], v[196:199], v[72:75]
    v_mul_f32 v86, v86, v168
    v_mul_f32 v87, v87, v168
    v_mfma_f32_16x16x32_bf16 v[36:39], v[144:147], v[108:111], v[36:39]
    ds_read_b128 v[156:159], v227 offset:0
    v_cvt_pk_bf16_f32 v118, v84, v85
    v_mfma_f32_16x16x32_bf16 v[0:3], v[140:143], v[108:111], v[0:3]
    v_cvt_pk_bf16_f32 v119, v86, v87
    v_permlane16_swap_b32 v116, v118
    s_waitcnt lgkmcnt(1)
    v_mfma_f32_16x16x32_bf16 v[32:35], v[204:207], v[152:155], v[32:35]
    v_permlane16_swap_b32 v117, v119
    buffer_store_dwordx4 v[116:119], v235, s[40:43], s13 offen sc1
    v_mfma_f32_16x16x32_bf16 v[68:71], v[152:155], v[208:211], v[68:71]
    v_cvt_pk_bf16_f32 v242, v92, v93
    v_cvt_pk_bf16_f32 v243, v94, v95
    v_mfma_f32_16x16x32_bf16 v[72:75], v[108:111], v[148:151], v[72:75]
    v_cndmask_b32 v18, v16, 0, s[58:59]
    v_cndmask_b32 v19, v17, 0, s[58:59]
    v_mfma_f32_16x16x32_bf16 v[4:7], v[140:143], v[112:115], v[4:7]
    v_cndmask_b32 v16, 0, v16, s[58:59]
    v_cndmask_b32 v17, 0, v17, s[58:59]
    v_mfma_f32_16x16x32_bf16 v[4:7], v[200:203], v[160:163], v[4:7]
    v_cndmask_b32 v58, v56, v52, s[58:59]
    v_cndmask_b32 v59, v57, v53, s[58:59]
    v_mfma_f32_16x16x32_bf16 v[124:127], v[52:55], v[16:19], v[212:215]
    v_cvt_pk_bf16_f32 v20, v20, v21
    v_cvt_pk_bf16_f32 v21, v22, v23
    v_cndmask_b32 v22, v20, 0, s[58:59]
    v_cndmask_b32 v23, v21, 0, s[58:59]
    s_waitcnt lgkmcnt(0)
    v_mfma_f32_16x16x32_bf16 v[36:39], v[204:207], v[156:159], v[36:39]
    v_cndmask_b32 v20, 0, v20, s[58:59]
    v_cndmask_b32 v21, 0, v21, s[58:59]
    v_mfma_f32_16x16x32_bf16 v[0:3], v[200:203], v[156:159], v[0:3]
    v_max3_f32 v172, v124, v125, v126
    v_max_f32 v172, v172, v127
    v_mfma_f32_16x16x32_bf16 v[128:131], v[56:59], v[20:23], v[212:215]
    v_cvt_pk_bf16_f32 v60, v60, v61
    v_cvt_pk_bf16_f32 v61, v62, v63
    v_mfma_f32_16x16x32_bf16 v[72:75], v[156:159], v[208:211], v[72:75]
    v_cvt_pk_bf16_f32 v240, v96, v97
    v_cvt_pk_bf16_f32 v241, v98, v99
    v_cvt_pk_bf16_f32 v64, v64, v65
    v_cvt_pk_bf16_f32 v65, v66, v67
    v_cvt_pk_bf16_f32 v238, v100, v101
    v_max3_f32 v176, v128, v129, v130
    v_max_f32 v176, v176, v131
    v_cvt_pk_bf16_f32 v239, v102, v103
    v_cndmask_b32 v62, v60, v56, s[58:59]
    v_permlane32_swap_b32 v172, v176
    v_max_f32 v173, v172, v176
    v_max_f32 v172, v172, v176
    v_cndmask_b32 v63, v61, v57, s[58:59]
    v_cvt_pk_bf16_f32 v24, v24, v25
    v_permlane16_swap_b32 v172, v173
    v_max_f32 v172, v172, v173
    v_mul_f32 v176, s56, -v172
    v_mul_f32 v172, s56, -v172
    v_cvt_pk_bf16_f32 v25, v26, v27
    v_cndmask_b32 v26, v24, 0, s[58:59]
    v_permlane32_swap_b32 v172, v176
    v_fma_f32 v124, v124, s56, v172
    v_fma_f32 v125, v125, s56, v172
    v_fma_f32 v126, v126, s56, v172
    v_fma_f32 v127, v127, s56, v172
    v_exp_f32 v124, v124
    v_exp_f32 v125, v125
    v_exp_f32 v126, v126
    v_exp_f32 v127, v127
    v_cvt_pk_bf16_f32 v16, v124, v125
    v_cvt_pk_bf16_f32 v17, v126, v127
    v_cndmask_b32 v18, 0, v16, s[60:61]
    v_cndmask_b32 v19, 0, v17, s[60:61]
    v_cndmask_b32 v16, v16, 0, s[60:61]
    v_cndmask_b32 v17, v17, 0, s[60:61]
    v_fma_f32 v128, v128, s56, v176
    v_fma_f32 v129, v129, s56, v176
    v_mfma_f32_16x16x32_bf16 v[172:175], v[220:223], v[16:19], 0
    v_fma_f32 v130, v130, s56, v176
    v_fma_f32 v131, v131, s56, v176
    v_mfma_f32_16x16x32_bf16 v[88:91], v[244:247], v[16:19], 0
    v_exp_f32 v128, v128
    v_exp_f32 v129, v129
    v_exp_f32 v130, v130
    v_exp_f32 v131, v131
    v_cvt_pk_bf16_f32 v20, v128, v129
    v_cvt_pk_bf16_f32 v21, v130, v131
    v_cndmask_b32 v22, 0, v20, s[60:61]
    v_cndmask_b32 v23, 0, v21, s[60:61]
    v_cndmask_b32 v20, v20, 0, s[60:61]
    v_cndmask_b32 v21, v21, 0, s[60:61]
    v_rcp_f32 v172, v172
    v_cndmask_b32 v27, v25, 0, s[58:59]
    v_mfma_f32_16x16x32_bf16 v[176:179], v[220:223], v[20:23], 0
    v_mul_f32 v88, v88, v172
    v_mul_f32 v89, v89, v172
    v_mfma_f32_16x16x32_bf16 v[92:95], v[242:245], v[20:23], 0
    v_mul_f32 v90, v90, v172
    v_mul_f32 v91, v91, v172
    v_cvt_pk_bf16_f32 v124, v88, v89
    v_cvt_pk_bf16_f32 v125, v90, v91
    v_cndmask_b32 v24, 0, v24, s[58:59]
    v_rcp_f32 v176, v176
    v_cndmask_b32 v25, 0, v25, s[58:59]
    v_cndmask_b32 v66, v64, v60, s[58:59]
    v_mul_f32 v92, v92, v176
    v_mfma_f32_16x16x32_bf16 v[132:135], v[60:63], v[24:27], v[212:215]
    v_mul_f32 v93, v93, v176
    v_mul_f32 v94, v94, v176
    v_mul_f32 v95, v95, v176
    v_cvt_pk_bf16_f32 v126, v92, v93
    v_cvt_pk_bf16_f32 v127, v94, v95
    v_cndmask_b32 v67, v65, v61, s[58:59]
    v_permlane16_swap_b32 v124, v126
    v_permlane16_swap_b32 v125, v127
    buffer_store_dwordx4 v[124:127], v235, s[40:43], s14 offen sc1
    v_cvt_pk_bf16_f32 v28, v28, v29
    v_cvt_pk_bf16_f32 v29, v30, v31
    v_cndmask_b32 v30, v28, 0, s[58:59]
    v_cndmask_b32 v31, v29, 0, s[58:59]
    v_cndmask_b32 v28, 0, v28, s[58:59]
    v_cndmask_b32 v29, 0, v29, s[58:59]
    v_max3_f32 v180, v132, v133, v134
    v_max_f32 v180, v180, v135
    v_mfma_f32_16x16x32_bf16 v[136:139], v[64:67], v[28:31], v[212:215]
    v_cvt_pk_bf16_f32 v32, v32, v33
    v_cvt_pk_bf16_f32 v33, v34, v35
    v_cvt_pk_bf16_f32 v254, v68, v69
    v_cvt_pk_bf16_f32 v255, v70, v71
    v_cvt_pk_bf16_f32 v36, v36, v37
    v_cvt_pk_bf16_f32 v37, v38, v39
    v_cvt_pk_bf16_f32 v252, v72, v73
    v_cvt_pk_bf16_f32 v253, v74, v75
    v_max3_f32 v184, v136, v137, v138
    v_max_f32 v184, v184, v139
    v_cndmask_b32 v38, v36, v32, s[58:59]
    v_cndmask_b32 v39, v37, v33, s[58:59]
    s_waitcnt vmcnt(1)
    s_cbranch_vccz L_fs10
    buffer_store_dword v237, v236, s[40:43], s45 offen offset:128
L_fb10:
    v_permlane32_swap_b32 v180, v184
    v_max_f32 v181, v180, v184
    v_max_f32 v180, v180, v184
    v_cvt_pk_bf16_f32 v0, v0, v1
    v_cvt_pk_bf16_f32 v1, v2, v3
    v_permlane16_swap_b32 v180, v181
    v_max_f32 v180, v180, v181
    v_mul_f32 v184, s56, -v180
    v_mul_f32 v180, s56, -v180
    v_cndmask_b32 v2, v0, 0, s[58:59]
    v_cndmask_b32 v3, v1, 0, s[58:59]
    v_permlane32_swap_b32 v180, v184
    v_fma_f32 v132, v132, s56, v180
    v_fma_f32 v133, v133, s56, v180
    v_fma_f32 v134, v134, s56, v180
    v_fma_f32 v135, v135, s56, v180
    v_exp_f32 v132, v132
    v_exp_f32 v133, v133
    v_exp_f32 v134, v134
    v_exp_f32 v135, v135
    v_cvt_pk_bf16_f32 v24, v132, v133
    v_cvt_pk_bf16_f32 v25, v134, v135
    v_cndmask_b32 v26, 0, v24, s[60:61]
    v_cndmask_b32 v27, 0, v25, s[60:61]
    v_cndmask_b32 v24, v24, 0, s[60:61]
    v_cndmask_b32 v25, v25, 0, s[60:61]
    v_fma_f32 v136, v136, s56, v184
    v_fma_f32 v137, v137, s56, v184
    v_mfma_f32_16x16x32_bf16 v[180:183], v[220:223], v[24:27], 0
    v_fma_f32 v138, v138, s56, v184
    v_fma_f32 v139, v139, s56, v184
    v_mfma_f32_16x16x32_bf16 v[96:99], v[240:243], v[24:27], 0
    v_exp_f32 v136, v136
    v_exp_f32 v137, v137
    v_exp_f32 v138, v138
    v_exp_f32 v139, v139
    v_cvt_pk_bf16_f32 v28, v136, v137
    v_cvt_pk_bf16_f32 v29, v138, v139
    v_cndmask_b32 v30, 0, v28, s[60:61]
    v_cndmask_b32 v31, 0, v29, s[60:61]
    v_cndmask_b32 v28, v28, 0, s[60:61]
    v_cndmask_b32 v29, v29, 0, s[60:61]
    v_rcp_f32 v180, v180
    v_cndmask_b32 v0, 0, v0, s[58:59]
    v_mfma_f32_16x16x32_bf16 v[184:187], v[220:223], v[28:31], 0
    v_mul_f32 v96, v96, v180
    v_mul_f32 v97, v97, v180
    v_mfma_f32_16x16x32_bf16 v[100:103], v[238:241], v[28:31], 0
    v_mul_f32 v98, v98, v180
    v_mul_f32 v99, v99, v180
    v_cvt_pk_bf16_f32 v132, v96, v97
    v_cvt_pk_bf16_f32 v133, v98, v99
    v_cndmask_b32 v1, 0, v1, s[58:59]
    v_rcp_f32 v184, v184
    v_cndmask_b32 v42, v40, v36, s[58:59]
    v_mfma_f32_16x16x32_bf16 v[108:111], v[36:39], v[0:3], v[216:219]
    v_mul_f32 v100, v100, v184
    v_mul_f32 v101, v101, v184
    v_mul_f32 v102, v102, v184
    v_mul_f32 v103, v103, v184
    v_cvt_pk_bf16_f32 v134, v100, v101
    v_cvt_pk_bf16_f32 v135, v102, v103
    v_cndmask_b32 v43, v41, v37, s[58:59]
    v_permlane16_swap_b32 v132, v134
    v_permlane16_swap_b32 v133, v135
    buffer_store_dwordx4 v[132:135], v235, s[40:43], s15 offen sc1
    v_cvt_pk_bf16_f32 v4, v4, v5
    v_cvt_pk_bf16_f32 v5, v6, v7
    v_cndmask_b32 v6, v4, 0, s[58:59]
    v_cndmask_b32 v7, v5, 0, s[58:59]
    v_cndmask_b32 v4, 0, v4, s[58:59]
    v_cndmask_b32 v5, 0, v5, s[58:59]
    v_max3_f32 v156, v108, v109, v110
    v_max_f32 v156, v156, v111
    v_mfma_f32_16x16x32_bf16 v[112:115], v[40:43], v[4:7], v[212:215]
    s_nop 7
    v_max3_f32 v160, v112, v113, v114
    v_max_f32 v160, v160, v115
    s_nop 1
    v_permlane32_swap_b32 v156, v160
    v_max_f32 v157, v156, v160
    v_max_f32 v156, v156, v160
    s_nop 1
    v_permlane16_swap_b32 v156, v157
    v_max_f32 v156, v156, v157
    v_mul_f32 v160, s56, -v156
    v_mul_f32 v156, s56, -v156
    s_nop 1
    v_permlane32_swap_b32 v156, v160
    v_fma_f32 v108, v108, s56, v156
    v_fma_f32 v109, v109, s56, v156
    v_fma_f32 v110, v110, s56, v156
    v_fma_f32 v111, v111, s56, v156
    v_exp_f32 v108, v108
    v_exp_f32 v109, v109
    v_exp_f32 v110, v110
    s_waitcnt vmcnt(2)
    s_cbranch_vccz L_fs11
    buffer_store_dword v237, v236, s[40:43], s45 offen offset:288
L_fb11:
    v_exp_f32 v111, v111
    v_cvt_pk_bf16_f32 v0, v108, v109
    v_cvt_pk_bf16_f32 v1, v110, v111
    v_cndmask_b32 v2, 0, v0, s[60:61]
    v_cndmask_b32 v3, 0, v1, s[60:61]
    v_cndmask_b32 v0, v0, 0, s[60:61]
    v_cndmask_b32 v1, v1, 0, s[60:61]
    v_fma_f32 v112, v112, s56, v160
    v_fma_f32 v113, v113, s56, v160
    v_mfma_f32_16x16x32_bf16 v[156:159], v[220:223], v[0:3], 0
    v_fma_f32 v114, v114, s56, v160
    v_fma_f32 v115, v115, s56, v160
    v_mfma_f32_16x16x32_bf16 v[72:75], v[252:255], v[0:3], 0
    v_exp_f32 v112, v112
    v_exp_f32 v113, v113
    v_exp_f32 v114, v114
    v_exp_f32 v115, v115
    v_cvt_pk_bf16_f32 v4, v112, v113
    v_cvt_pk_bf16_f32 v5, v114, v115
    v_cndmask_b32 v6, 0, v4, s[60:61]
    v_cndmask_b32 v7, 0, v5, s[60:61]
    v_cndmask_b32 v4, v4, 0, s[60:61]
    v_cndmask_b32 v5, v5, 0, s[60:61]
    v_rcp_f32 v156, v156
    s_nop 0
    v_mfma_f32_16x16x32_bf16 v[160:163], v[220:223], v[4:7], 0
    v_mul_f32 v72, v72, v156
    v_mul_f32 v73, v73, v156
    v_mfma_f32_16x16x32_bf16 v[76:79], v[250:253], v[4:7], 0
    v_mul_f32 v74, v74, v156
    v_mul_f32 v75, v75, v156
    v_cvt_pk_bf16_f32 v108, v72, v73
    v_cvt_pk_bf16_f32 v109, v74, v75
    s_nop 0
    v_rcp_f32 v160, v160
    s_nop 1
    v_mul_f32 v76, v76, v160
    v_mul_f32 v77, v77, v160
    v_mul_f32 v78, v78, v160
    v_mul_f32 v79, v79, v160
    v_cvt_pk_bf16_f32 v110, v76, v77
    v_cvt_pk_bf16_f32 v111, v78, v79
    s_nop 0
    v_permlane16_swap_b32 v108, v110
    v_permlane16_swap_b32 v109, v111
    buffer_store_dwordx4 v[108:111], v235, s[40:43], s12 offen sc1
    s_waitcnt vmcnt(2)
    s_cbranch_vccz L_fs12
    buffer_store_dword v237, v236, s[40:43], s45 offen offset:448
L_fb12:
    s_waitcnt vmcnt(1)
    s_cbranch_vccz L_fs13
    buffer_store_dword v237, v236, s[40:43], s45 offen offset:96
L_fb13:
    s_endpgm
L_fs10:
    buffer_store_dword v237, v236, s[40:43], s45 offen offset:128 sc1
    s_branch L_fb10
L_fs11:
    buffer_store_dword v237, v236, s[40:43], s45 offen offset:288 sc1
    s_branch L_fb11
L_fs12:
    buffer_store_dword v237, v236, s[40:43], s45 offen offset:448 sc1
    s_branch L_fb12
L_fs13:
    buffer_store_dword v237, v236, s[40:43], s45 offen offset:96 sc1
    s_branch L_fb13
L_ve1:
.fill (3520-(L_ve1-L_w1))/4, 4, 0xbf800000
    .p2align 12
L_w2:
    s_branch L_wback
    s_nop 0
L_v2:
    s_waitcnt lgkmcnt(0)
    s_barrier
    s_setprio 3
    v_mfma_f32_16x16x32_bf16 v[48:51], v[192:195], v[168:171], v[48:51]
    v_mov_b32 v224, 0
    ds_read_b64_tr_b16 v[144:145], v231 offset:1024
    v_mfma_f32_16x16x32_bf16 v[12:15], v[188:191], v[168:171], v[12:15]
    ds_read_b64_tr_b16 v[146:147], v231 offset:1536
    ds_read_b64_tr_b16 v[148:149], v231 offset:2048
    v_mfma_f32_16x16x32_bf16 v[84:87], v[168:171], v[196:199], v[84:87]
    ds_read_b64_tr_b16 v[150:151], v231 offset:2560
    ds_read_b64_tr_b16 v[140:141], v231 offset:0
    v_mfma_f32_16x16x32_bf16 v[52:55], v[192:195], v[172:175], v[52:55]
    ds_read_b64_tr_b16 v[142:143], v231 offset:512
    ds_read_b64_tr_b16 v[204:205], v231 offset:13312
    v_mfma_f32_16x16x32_bf16 v[16:19], v[188:191], v[172:175], v[16:19]
    ds_read_b64_tr_b16 v[206:207], v231 offset:13824
    ds_read_b64_tr_b16 v[208:209], v231 offset:14336
    v_mfma_f32_16x16x32_bf16 v[88:91], v[172:175], v[196:199], v[88:91]
    ds_read_b64_tr_b16 v[210:211], v231 offset:14848
    ds_read_b64_tr_b16 v[200:201], v231 offset:12288
    v_mfma_f32_16x16x32_bf16 v[56:59], v[192:195], v[176:179], v[56:59]
    ds_read_b64_tr_b16 v[202:203], v231 offset:12800
    ds_read_b128 v[120:123], v226 offset:6144
    v_mfma_f32_16x16x32_bf16 v[20:23], v[188:191], v[176:179], v[20:23]
    ds_read_b128 v[168:171], v227 offset:6144
    s_waitcnt lgkmcnt(9)
    ds_read_b128 v[124:127], v226 offset:8192
    v_mfma_f32_16x16x32_bf16 v[92:95], v[176:179], v[196:199], v[92:95]
    ds_read_b128 v[172:175], v227 offset:8192
    ds_read_b128 v[128:131], v226 offset:10240
    v_mfma_f32_16x16x32_bf16 v[60:63], v[192:195], v[180:183], v[60:63]
    ds_read_b128 v[176:179], v227 offset:10240
    ds_read_b128 v[132:135], v226 offset:12288
    v_mfma_f32_16x16x32_bf16 v[24:27], v[188:191], v[180:183], v[24:27]
    s_waitcnt lgkmcnt(9)
    ds_read_b128 v[136:139], v226 offset:14336
    ds_read_b128 v[104:107], v233 offset:7168
    v_mfma_f32_16x16x32_bf16 v[96:99], v[180:183], v[196:199], v[96:99]
    ds_read_b128 v[108:111], v226 offset:0
    ds_read_b128 v[112:115], v226 offset:2048
    v_mfma_f32_16x16x32_bf16 v[64:67], v[192:195], v[184:187], v[64:67]
    ds_read_b128 v[180:183], v227 offset:12288
    s_waitcnt lgkmcnt(9)
    ds_read_b128 v[116:119], v226 offset:4096
    v_mfma_f32_16x16x32_bf16 v[28:31], v[188:191], v[184:187], v[28:31]
    ds_read_b32 v225, v224
    v_mfma_f32_16x16x32_bf16 v[100:103], v[184:187], v[196:199], v[100:103]
    v_mfma_f32_16x16x32_bf16 v[48:51], v[144:147], v[120:123], v[48:51]
    ds_read_b128 v[184:187], v227 offset:14336
    v_mfma_f32_16x16x32_bf16 v[84:87], v[120:123], v[148:151], v[84:87]
    v_mfma_f32_16x16x32_bf16 v[48:51], v[204:207], v[168:171], v[48:51]
    v_mfma_f32_16x16x32_bf16 v[84:87], v[168:171], v[208:211], v[84:87]
    v_mfma_f32_16x16x32_bf16 v[52:55], v[144:147], v[124:127], v[52:55]
    v_mfma_f32_16x16x32_bf16 v[16:19], v[140:143], v[124:127], v[16:19]
    v_mfma_f32_16x16x32_bf16 v[88:91], v[124:127], v[148:151], v[88:91]
    s_waitcnt lgkmcnt(1)
    v_cmp_ne_u32 vcc, 0, v225
    v_mfma_f32_16x16x32_bf16 v[52:55], v[204:207], v[172:175], v[52:55]
    v_mfma_f32_16x16x32_bf16 v[16:19], v[200:203], v[172:175], v[16:19]
    v_cvt_pk_bf16_f32 v48, v48, v49
    v_mfma_f32_16x16x32_bf16 v[88:91], v[172:175], v[208:211], v[88:91]
    v_cvt_pk_bf16_f32 v49, v50, v51
    v_cvt_pk_bf16_f32 v246, v84, v85
    v_mfma_f32_16x16x32_bf16 v[56:59], v[144:147], v[128:131], v[56:59]
    v_cvt_pk_bf16_f32 v247, v86, v87
    s_nop 0
    v_cvt_pk_bf16_f32 v52, v52, v53
    v_mfma_f32_16x16x32_bf16 v[20:23], v[140:143], v[128:131], v[20:23]
    v_cvt_pk_bf16_f32 v53, v54, v55
    v_cndmask_b32 v54, v52, v48, s[58:59]
    v_mfma_f32_16x16x32_bf16 v[92:95], v[128:131], v[148:151], v[92:95]
    v_cvt_pk_bf16_f32 v244, v88, v89
    v_cvt_pk_bf16_f32 v245, v90, v91
    v_mfma_f32_16x16x32_bf16 v[56:59], v[204:207], v[176:179], v[56:59]
    v_cndmask_b32 v55, v53, v49, s[58:59]
    v_cvt_pk_bf16_f32 v16, v16, v17
    v_mfma_f32_16x16x32_bf16 v[20:23], v[200:203], v[176:179], v[20:23]
    v_cvt_pk_bf16_f32 v17, v18, v19
    v_cndmask_b32 v18, v16, 0, s[58:59]
    v_mfma_f32_16x16x32_bf16 v[92:95], v[176:179], v[208:211], v[92:95]
    v_cndmask_b32 v19, v17, 0, s[58:59]
    v_cndmask_b32 v16, 0, v16, s[58:59]
    v_mfma_f32_16x16x32_bf16 v[60:63], v[144:147], v[132:135], v[60:63]
    v_cvt_pk_bf16_f32 v56, v56, v57
    v_cvt_pk_bf16_f32 v57, v58, v59
    v_mfma_f32_16x16x32_bf16 v[24:27], v[140:143], v[132:135], v[24:27]
    v_cndmask_b32 v17, 0, v17, s[58:59]
    v_cndmask_b32 v58, v56, v52, s[58:59]
    v_mfma_f32_16x16x32_bf16 v[96:99], v[132:135], v[148:151], v[96:99]
    v_cvt_pk_bf16_f32 v242, v92, v93
    v_cvt_pk_bf16_f32 v243, v94, v95
    v_mfma_f32_16x16x32_bf16 v[124:127], v[52:55], v[16:19], v[212:215]
    v_cndmask_b32 v59, v57, v53, s[58:59]
    v_cvt_pk_bf16_f32 v20, v20, v21
    v_mfma_f32_16x16x32_bf16 v[60:63], v[204:207], v[180:183], v[60:63]
    v_cvt_pk_bf16_f32 v21, v22, v23
    v_cndmask_b32 v22, v20, 0, s[58:59]
    v_mfma_f32_16x16x32_bf16 v[24:27], v[200:203], v[180:183], v[24:27]
    v_cndmask_b32 v23, v21, 0, s[58:59]
    v_cndmask_b32 v20, 0, v20, s[58:59]
    v_mfma_f32_16x16x32_bf16 v[96:99], v[180:183], v[208:211], v[96:99]
    v_cndmask_b32 v21, 0, v21, s[58:59]
    v_max3_f32 v172, v124, v125, v126
    v_mfma_f32_16x16x32_bf16 v[64:67], v[144:147], v[136:139], v[64:67]
    v_max_f32 v172, v172, v127
    v_cvt_pk_bf16_f32 v60, v60, v61
    v_mfma_f32_16x16x32_bf16 v[128:131], v[56:59], v[20:23], v[212:215]
    v_cvt_pk_bf16_f32 v61, v62, v63
    v_cndmask_b32 v62, v60, v56, s[58:59]
    v_mfma_f32_16x16x32_bf16 v[28:31], v[140:143], v[136:139], v[28:31]
    v_cvt_pk_bf16_f32 v240, v96, v97
    v_cvt_pk_bf16_f32 v241, v98, v99
    v_mfma_f32_16x16x32_bf16 v[100:103], v[136:139], v[148:151], v[100:103]
    v_cndmask_b32 v63, v61, v57, s[58:59]
    v_cvt_pk_bf16_f32 v24, v24, v25
    s_waitcnt lgkmcnt(0)
    v_mfma_f32_16x16x32_bf16 v[64:67], v[204:207], v[184:187], v[64:67]
    v_max3_f32 v176, v128, v129, v130
    v_max_f32 v176, v176, v131
    v_mfma_f32_16x16x32_bf16 v[28:31], v[200:203], v[184:187], v[28:31]
    v_cvt_pk_bf16_f32 v25, v26, v27
    v_permlane32_swap_b32 v172, v176
    v_mfma_f32_16x16x32_bf16 v[100:103], v[184:187], v[208:211], v[100:103]
    v_max_f32 v173, v172, v176
    v_max_f32 v172, v172, v176
    v_mfma_f32_16x16x32_bf16 v[32:35], v[192:195], v[152:155], v[32:35]
    v_cvt_pk_bf16_f32 v64, v64, v65
    v_permlane16_swap_b32 v172, v173
    v_mfma_f32_16x16x32_bf16 v[68:71], v[152:155], v[196:199], v[68:71]
    v_max_f32 v172, v172, v173
    v_mul_f32 v176, s56, -v172
    v_mfma_f32_16x16x32_bf16 v[32:35], v[144:147], v[104:107], v[32:35]
    ds_read_b128 v[152:155], v234 offset:7168
    v_mul_f32 v172, s56, -v172
    v_mfma_f32_16x16x32_bf16 v[68:71], v[104:107], v[148:151], v[68:71]
    v_cvt_pk_bf16_f32 v65, v66, v67
    v_permlane32_swap_b32 v172, v176
    v_mfma_f32_16x16x32_bf16 v[36:39], v[192:195], v[156:159], v[36:39]
    v_fma_f32 v124, v124, s56, v172
    v_fma_f32 v125, v125, s56, v172
    v_mfma_f32_16x16x32_bf16 v[0:3], v[188:191], v[156:159], v[0:3]
    v_fma_f32 v126, v126, s56, v172
    v_fma_f32 v127, v127, s56, v172
    v_mfma_f32_16x16x32_bf16 v[72:75], v[156:159], v[196:199], v[72:75]
    v_exp_f32 v124, v124
    v_mfma_f32_16x16x32_bf16 v[36:39], v[144:147], v[108:111], v[36:39]
    ds_read_b128 v[156:159], v227 offset:0
    v_exp_f32 v125, v125
    v_mfma_f32_16x16x32_bf16 v[0:3], v[140:143], v[108:111], v[0:3]
    v_exp_f32 v126, v126
    v_mfma_f32_16x16x32_bf16 v[72:75], v[108:111], v[148:151], v[72:75]
    v_exp_f32 v127, v127
    v_mfma_f32_16x16x32_bf16 v[40:43], v[192:195], v[160:163], v[40:43]
    v_cvt_pk_bf16_f32 v16, v124, v125
    v_cvt_pk_bf16_f32 v17, v126, v127
    s_waitcnt lgkmcnt(1)
    v_mfma_f32_16x16x32_bf16 v[32:35], v[204:207], v[152:155], v[32:35]
    v_cndmask_b32 v18, 0, v16, s[60:61]
    v_cndmask_b32 v19, 0, v17, s[60:61]
    v_mfma_f32_16x16x32_bf16 v[68:71], v[152:155], v[208:211], v[68:71]
    v_cndmask_b32 v16, v16, 0, s[60:61]
    v_cndmask_b32 v17, v17, 0, s[60:61]
    v_mfma_f32_16x16x32_bf16 v[4:7], v[188:191], v[160:163], v[4:7]
    v_fma_f32 v128, v128, s56, v176
    v_fma_f32 v129, v129, s56, v176
    v_mfma_f32_16x16x32_bf16 v[172:175], v[220:223], v[16:19], 0
    v_fma_f32 v130, v130, s56, v176
    v_fma_f32 v131, v131, s56, v176
    v_mfma_f32_16x16x32_bf16 v[88:91], v[244:247], v[16:19], 0
    v_exp_f32 v128, v128
    s_waitcnt lgkmcnt(0)
    v_mfma_f32_16x16x32_bf16 v[36:39], v[204:207], v[156:159], v[36:39]
    v_exp_f32 v129, v129
    v_mfma_f32_16x16x32_bf16 v[0:3], v[200:203], v[156:159], v[0:3]
    v_exp_f32 v130, v130
    v_mfma_f32_16x16x32_bf16 v[72:75], v[156:159], v[208:211], v[72:75]
    v_exp_f32 v131, v131
    v_mfma_f32_16x16x32_bf16 v[76:79], v[160:163], v[196:199], v[76:79]
    v_cvt_pk_bf16_f32 v20, v128, v129
    v_cvt_pk_bf16_f32 v21, v130, v131
    v_mfma_f32_16x16x32_bf16 v[40:43], v[144:147], v[112:115], v[40:43]
    ds_read_b128 v[160:163], v227 offset:2048
    v_cndmask_b32 v22, 0, v20, s[60:61]
    v_mfma_f32_16x16x32_bf16 v[4:7], v[140:143], v[112:115], v[4:7]
    v_cndmask_b32 v23, 0, v21, s[60:61]
    v_cndmask_b32 v20, v20, 0, s[60:61]
    v_mfma_f32_16x16x32_bf16 v[76:79], v[112:115], v[148:151], v[76:79]
    v_cndmask_b32 v21, v21, 0, s[60:61]
    v_rcp_f32 v172, v172
    v_mfma_f32_16x16x32_bf16 v[44:47], v[192:195], v[164:167], v[44:47]
    v_mul_f32 v88, v88, v172
    v_mul_f32 v89, v89, v172
    v_mfma_f32_16x16x32_bf16 v[176:179], v[220:223], v[20:23], 0
    v_mul_f32 v90, v90, v172
    v_mul_f32 v91, v91, v172
    v_mfma_f32_16x16x32_bf16 v[92:95], v[242:245], v[20:23], 0
    v_cvt_pk_bf16_f32 v124, v88, v89
    v_cvt_pk_bf16_f32 v125, v90, v91
    v_mfma_f32_16x16x32_bf16 v[8:11], v[188:191], v[164:167], v[8:11]
    v_cvt_pk_bf16_f32 v238, v100, v101
    v_cvt_pk_bf16_f32 v239, v102, v103
    v_mfma_f32_16x16x32_bf16 v[80:83], v[164:167], v[196:199], v[80:83]
    v_rcp_f32 v176, v176
    v_mfma_f32_16x16x32_bf16 v[44:47], v[144:147], v[116:119], v[44:47]
    ds_read_b128 v[164:167], v227 offset:4096
    v_mul_f32 v92, v92, v176
    s_waitcnt lgkmcnt(1)
    v_mfma_f32_16x16x32_bf16 v[40:43], v[204:207], v[160:163], v[40:43]
    v_mul_f32 v93, v93, v176
    v_mul_f32 v94, v94, v176
    v_mfma_f32_16x16x32_bf16 v[4:7], v[200:203], v[160:163], v[4:7]
    v_mul_f32 v95, v95, v176
    v_cvt_pk_bf16_f32 v126, v92, v93
    v_mfma_f32_16x16x32_bf16 v[76:79], v[160:163], v[208:211], v[76:79]
    v_cvt_pk_bf16_f32 v127, v94, v95
    v_permlane16_swap_b32 v124, v126
    v_mfma_f32_16x16x32_bf16 v[8:11], v[140:143], v[116:119], v[8:11]
    v_permlane16_swap_b32 v125, v127
    buffer_store_dwordx4 v[124:127], v235, s[40:43], s14 offen sc1
    v_mfma_f32_16x16x32_bf16 v[80:83], v[116:119], v[148:151], v[80:83]
    v_cndmask_b32 v26, v24, 0, s[58:59]
    v_cndmask_b32 v27, v25, 0, s[58:59]
    v_mfma_f32_16x16x32_bf16 v[12:15], v[140:143], v[120:123], v[12:15]
    v_cndmask_b32 v24, 0, v24, s[58:59]
    v_cndmask_b32 v25, 0, v25, s[58:59]
    v_mfma_f32_16x16x32_bf16 v[12:15], v[200:203], v[168:171], v[12:15]
    v_cndmask_b32 v66, v64, v60, s[58:59]
    v_cndmask_b32 v67, v65, v61, s[58:59]
    v_mfma_f32_16x16x32_bf16 v[132:135], v[60:63], v[24:27], v[212:215]
    v_cvt_pk_bf16_f32 v28, v28, v29
    v_cvt_pk_bf16_f32 v29, v30, v31
    s_waitcnt lgkmcnt(0)
    v_mfma_f32_16x16x32_bf16 v[44:47], v[204:207], v[164:167], v[44:47]
    v_cndmask_b32 v30, v28, 0, s[58:59]
    v_cndmask_b32 v31, v29, 0, s[58:59]
    v_mfma_f32_16x16x32_bf16 v[8:11], v[200:203], v[164:167], v[8:11]
    v_cndmask_b32 v28, 0, v28, s[58:59]
    v_cndmask_b32 v29, 0, v29, s[58:59]
    v_mfma_f32_16x16x32_bf16 v[80:83], v[164:167], v[208:211], v[80:83]
    v_max3_f32 v180, v132, v133, v134
    v_max_f32 v180, v180, v135
    v_mfma_f32_16x16x32_bf16 v[136:139], v[64:67], v[28:31], v[212:215]
    v_cvt_pk_bf16_f32 v32, v32, v33
    v_cvt_pk_bf16_f32 v33, v34, v35
    v_cvt_pk_bf16_f32 v254, v68, v69
    v_cvt_pk_bf16_f32 v255, v70, v71
    v_cvt_pk_bf16_f32 v36, v36, v37
    v_cvt_pk_bf16_f32 v37, v38, v39
    v_cvt_pk_bf16_f32 v252, v72, v73
    v_cvt_pk_bf16_f32 v253, v74, v75
    v_max3_f32 v184, v136, v137, v138
    v_max_f32 v184, v184, v139
    v_cvt_pk_bf16_f32 v40, v40, v41
    v_cvt_pk_bf16_f32 v41, v42, v43
    v_permlane32_swap_b32 v180, v184
    v_max_f32 v181, v180, v184
    v_max_f32 v180, v180, v184
    v_cvt_pk_bf16_f32 v250, v76, v77
    v_cvt_pk_bf16_f32 v251, v78, v79
    v_permlane16_swap_b32 v180, v181
    v_max_f32 v180, v180, v181
    v_mul_f32 v184, s56, -v180
    v_mul_f32 v180, s56, -v180
    v_cndmask_b32 v38, v36, v32, s[58:59]
    v_cndmask_b32 v39, v37, v33, s[58:59]
    v_permlane32_swap_b32 v180, v184
    v_fma_f32 v132, v132, s56, v180
    v_fma_f32 v133, v133, s56, v180
    v_fma_f32 v134, v134, s56, v180
    v_fma_f32 v135, v135, s56, v180
    v_exp_f32 v132, v132
    v_exp_f32 v133, v133
    v_exp_f32 v134, v134
    v_exp_f32 v135, v135
    v_cvt_pk_bf16_f32 v24, v132, v133
    v_cvt_pk_bf16_f32 v25, v134, v135
    v_cndmask_b32 v26, 0, v24, s[60:61]
    v_cndmask_b32 v27, 0, v25, s[60:61]
    v_cndmask_b32 v24, v24, 0, s[60:61]
    v_cndmask_b32 v25, v25, 0, s[60:61]
    v_fma_f32 v136, v136, s56, v184
    v_fma_f32 v137, v137, s56, v184
    v_mfma_f32_16x16x32_bf16 v[180:183], v[220:223], v[24:27], 0
    v_fma_f32 v138, v138, s56, v184
    v_fma_f32 v139, v139, s56, v184
    v_mfma_f32_16x16x32_bf16 v[96:99], v[240:243], v[24:27], 0
    v_exp_f32 v136, v136
    v_exp_f32 v137, v137
    v_exp_f32 v138, v138
    v_exp_f32 v139, v139
    v_cvt_pk_bf16_f32 v28, v136, v137
    v_cvt_pk_bf16_f32 v29, v138, v139
    v_cndmask_b32 v30, 0, v28, s[60:61]
    v_cndmask_b32 v31, 0, v29, s[60:61]
    v_cndmask_b32 v28, v28, 0, s[60:61]
    v_cndmask_b32 v29, v29, 0, s[60:61]
    v_rcp_f32 v180, v180
    v_cvt_pk_bf16_f32 v0, v0, v1
    v_mfma_f32_16x16x32_bf16 v[184:187], v[220:223], v[28:31], 0
    v_mul_f32 v96, v96, v180
    v_mul_f32 v97, v97, v180
    v_mfma_f32_16x16x32_bf16 v[100:103], v[238:241], v[28:31], 0
    v_mul_f32 v98, v98, v180
    v_mul_f32 v99, v99, v180
    v_cvt_pk_bf16_f32 v132, v96, v97
    v_cvt_pk_bf16_f32 v133, v98, v99
    v_cvt_pk_bf16_f32 v1, v2, v3
    v_rcp_f32 v184, v184
    v_cndmask_b32 v2, v0, 0, s[58:59]
    v_cndmask_b32 v3, v1, 0, s[58:59]
    v_mul_f32 v100, v100, v184
    v_mul_f32 v101, v101, v184
    v_mul_f32 v102, v102, v184
    v_mul_f32 v103, v103, v184
    v_cvt_pk_bf16_f32 v134, v100, v101
    v_cvt_pk_bf16_f32 v135, v102, v103
    v_cndmask_b32 v0, 0, v0, s[58:59]
    v_permlane16_swap_b32 v132, v134
    v_permlane16_swap_b32 v133, v135
    buffer_store_dwordx4 v[132:135], v235, s[40:43], s15 offen sc1
    v_cndmask_b32 v1, 0, v1, s[58:59]
    v_cndmask_b32 v42, v40, v36, s[58:59]
    v_cndmask_b32 v43, v41, v37, s[58:59]
    v_mfma_f32_16x16x32_bf16 v[108:111], v[36:39], v[0:3], v[216:219]
    v_cvt_pk_bf16_f32 v4, v4, v5
    v_cvt_pk_bf16_f32 v5, v6, v7
    v_cndmask_b32 v6, v4, 0, s[58:59]
    v_cndmask_b32 v7, v5, 0, s[58:59]
    v_cndmask_b32 v4, 0, v4, s[58:59]
    v_cndmask_b32 v5, 0, v5, s[58:59]
    v_cvt_pk_bf16_f32 v44, v44, v45
    v_cvt_pk_bf16_f32 v45, v46, v47
    v_mfma_f32_16x16x32_bf16 v[112:115], v[40:43], v[4:7], v[212:215]
    v_max3_f32 v156, v108, v109, v110
    v_max_f32 v156, v156, v111
    v_cvt_pk_bf16_f32 v248, v80, v81
    v_cvt_pk_bf16_f32 v249, v82, v83
    v_cndmask_b32 v46, v44, v40, s[58:59]
    v_cndmask_b32 v47, v45, v41, s[58:59]
    v_cvt_pk_bf16_f32 v8, v8, v9
    v_cvt_pk_bf16_f32 v9, v10, v11
    v_max3_f32 v160, v112, v113, v114
    v_max_f32 v160, v160, v115
    v_cndmask_b32 v10, v8, 0, s[58:59]
    v_cndmask_b32 v11, v9, 0, s[58:59]
    s_waitcnt vmcnt(1)
    s_cbranch_vccz L_fs20
    buffer_store_dword v237, v236, s[40:43], s45 offen offset:256
L_fb20:
    v_permlane32_swap_b32 v156, v160
    v_max_f32 v157, v156, v160
    v_max_f32 v156, v156, v160
    v_cndmask_b32 v8, 0, v8, s[58:59]
    v_cndmask_b32 v9, 0, v9, s[58:59]
    v_permlane16_swap_b32 v156, v157
    v_max_f32 v156, v156, v157
    v_mfma_f32_16x16x32_bf16 v[116:119], v[44:47], v[8:11], v[212:215]
    v_mul_f32 v160, s56, -v156
    v_mul_f32 v156, s56, -v156
    v_cndmask_b32 v50, v48, v44, s[58:59]
    v_cndmask_b32 v51, v49, v45, s[58:59]
    v_permlane32_swap_b32 v156, v160
    v_fma_f32 v108, v108, s56, v156
    v_fma_f32 v109, v109, s56, v156
    v_fma_f32 v110, v110, s56, v156
    v_fma_f32 v111, v111, s56, v156
    v_exp_f32 v108, v108
    v_exp_f32 v109, v109
    v_exp_f32 v110, v110
    v_exp_f32 v111, v111
    v_cvt_pk_bf16_f32 v0, v108, v109
    v_cvt_pk_bf16_f32 v1, v110, v111
    v_cndmask_b32 v2, 0, v0, s[60:61]
    v_cndmask_b32 v3, 0, v1, s[60:61]
    v_cndmask_b32 v0, v0, 0, s[60:61]
    v_cndmask_b32 v1, v1, 0, s[60:61]
    v_fma_f32 v112, v112, s56, v160
    v_fma_f32 v113, v113, s56, v160
    v_mfma_f32_16x16x32_bf16 v[156:159], v[220:223], v[0:3], 0
    v_fma_f32 v114, v114, s56, v160
    v_fma_f32 v115, v115, s56, v160
    v_mfma_f32_16x16x32_bf16 v[72:75], v[252:255], v[0:3], 0
    v_exp_f32 v112, v112
    v_exp_f32 v113, v113
    v_exp_f32 v114, v114
    v_exp_f32 v115, v115
    v_cvt_pk_bf16_f32 v4, v112, v113
    v_cvt_pk_bf16_f32 v5, v114, v115
    v_cndmask_b32 v6, 0, v4, s[60:61]
    v_cndmask_b32 v7, 0, v5, s[60:61]
    v_cndmask_b32 v4, v4, 0, s[60:61]
    v_cndmask_b32 v5, v5, 0, s[60:61]
    v_rcp_f32 v156, v156
    v_cvt_pk_bf16_f32 v12, v12, v13
    v_mfma_f32_16x16x32_bf16 v[160:163], v[220:223], v[4:7], 0
    v_mul_f32 v72, v72, v156
    v_mul_f32 v73, v73, v156
    v_mfma_f32_16x16x32_bf16 v[76:79], v[250:253], v[4:7], 0
    v_mul_f32 v74, v74, v156
    v_mul_f32 v75, v75, v156
    v_cvt_pk_bf16_f32 v108, v72, v73
    v_cvt_pk_bf16_f32 v109, v74, v75
    v_cvt_pk_bf16_f32 v13, v14, v15
    v_rcp_f32 v160, v160
    v_cndmask_b32 v14, v12, 0, s[58:59]
    v_cndmask_b32 v15, v13, 0, s[58:59]
    v_mul_f32 v76, v76, v160
    v_mul_f32 v77, v77, v160
    v_mul_f32 v78, v78, v160
    v_mul_f32 v79, v79, v160
    v_cvt_pk_bf16_f32 v110, v76, v77
    v_cvt_pk_bf16_f32 v111, v78, v79
    v_cndmask_b32 v12, 0, v12, s[58:59]
    v_permlane16_swap_b32 v108, v110
    v_permlane16_swap_b32 v109, v111
    buffer_store_dwordx4 v[108:111], v235, s[40:43], s12 offen sc1
    v_cndmask_b32 v13, 0, v13, s[58:59]
    v_max3_f32 v164, v116, v117, v118
    v_max_f32 v164, v164, v119
    v_mfma_f32_16x16x32_bf16 v[120:123], v[48:51], v[12:15], v[212:215]
    s_nop 7
    v_max3_f32 v168, v120, v121, v122
    v_max_f32 v168, v168, v123
    s_nop 1
    v_permlane32_swap_b32 v164, v168
    v_max_f32 v165, v164, v168
    v_max_f32 v164, v164, v168
    s_nop 1
    v_permlane16_swap_b32 v164, v165
    v_max_f32 v164, v164, v165
    v_mul_f32 v168, s56, -v164
    v_mul_f32 v164, s56, -v164
    s_nop 1
    v_permlane32_swap_b32 v164, v168
    v_fma_f32 v116, v116, s56, v164
    v_fma_f32 v117, v117, s56, v164
    v_fma_f32 v118, v118, s56, v164
    v_fma_f32 v119, v119, s56, v164
    v_exp_f32 v116, v116
    v_exp_f32 v117, v117
    v_exp_f32 v118, v118
    s_waitcnt vmcnt(2)
    s_cbranch_vccz L_fs21
    buffer_store_dword v237, v236, s[40:43], s45 offen offset:416
L_fb21:
    v_exp_f32 v119, v119
    v_cvt_pk_bf16_f32 v8, v116, v117
    v_cvt_pk_bf16_f32 v9, v118, v119
    v_cndmask_b32 v10, 0, v8, s[60:61]
    v_cndmask_b32 v11, 0, v9, s[60:61]
    v_cndmask_b32 v8, v8, 0, s[60:61]
    v_cndmask_b32 v9, v9, 0, s[60:61]
    v_fma_f32 v120, v120, s56, v168
    v_fma_f32 v121, v121, s56, v168
    v_mfma_f32_16x16x32_bf16 v[164:167], v[220:223], v[8:11], 0
    v_fma_f32 v122, v122, s56, v168
    v_fma_f32 v123, v123, s56, v168
    v_mfma_f32_16x16x32_bf16 v[80:83], v[248:251], v[8:11], 0
    v_exp_f32 v120, v120
    v_exp_f32 v121, v121
    v_exp_f32 v122, v122
    v_exp_f32 v123, v123
    v_cvt_pk_bf16_f32 v12, v120, v121
    v_cvt_pk_bf16_f32 v13, v122, v123
    v_cndmask_b32 v14, 0, v12, s[60:61]
    v_cndmask_b32 v15, 0, v13, s[60:61]
    v_cndmask_b32 v12, v12, 0, s[60:61]
    v_cndmask_b32 v13, v13, 0, s[60:61]
    v_rcp_f32 v164, v164
    s_nop 0
    v_mfma_f32_16x16x32_bf16 v[168:171], v[220:223], v[12:15], 0
    v_mul_f32 v80, v80, v164
    v_mul_f32 v81, v81, v164
    v_mfma_f32_16x16x32_bf16 v[84:87], v[246:249], v[12:15], 0
    v_mul_f32 v82, v82, v164
    v_mul_f32 v83, v83, v164
    v_cvt_pk_bf16_f32 v116, v80, v81
    v_cvt_pk_bf16_f32 v117, v82, v83
    s_nop 0
    v_rcp_f32 v168, v168
    s_nop 1
    v_mul_f32 v84, v84, v168
    v_mul_f32 v85, v85, v168
    v_mul_f32 v86, v86, v168
    v_mul_f32 v87, v87, v168
    v_cvt_pk_bf16_f32 v118, v84, v85
    v_cvt_pk_bf16_f32 v119, v86, v87
    s_nop 0
    v_permlane16_swap_b32 v116, v118
    v_permlane16_swap_b32 v117, v119
    buffer_store_dwordx4 v[116:119], v235, s[40:43], s13 offen sc1
    s_waitcnt vmcnt(2)
    s_cbranch_vccz L_fs22
    buffer_store_dword v237, v236, s[40:43], s45 offen offset:64
L_fb22:
    s_waitcnt vmcnt(1)
    s_cbranch_vccz L_fs23
    buffer_store_dword v237, v236, s[40:43], s45 offen offset:224
L_fb23:
    s_endpgm
L_fs20:
    buffer_store_dword v237, v236, s[40:43], s45 offen offset:256 sc1
    s_branch L_fb20
L_fs21:
    buffer_store_dword v237, v236, s[40:43], s45 offen offset:416 sc1
    s_branch L_fb21
L_fs22:
    buffer_store_dword v237, v236, s[40:43], s45 offen offset:64 sc1
    s_branch L_fb22
L_fs23:
    buffer_store_dword v237, v236, s[40:43], s45 offen offset:224 sc1
    s_branch L_fb23
L_ve2:
.fill (3520-(L_ve2-L_w2))/4, 4, 0xbf800000
    .p2align 12
L_w3:
    s_branch L_wback
    s_nop 0
L_v3:
    s_waitcnt lgkmcnt(0)
    s_barrier
    s_setprio 3
    v_mfma_f32_16x16x32_bf16 v[56:59], v[192:195], v[176:179], v[56:59]
    v_mov_b32 v224, 0
    ds_read_b64_tr_b16 v[144:145], v231 offset:1024
    v_mfma_f32_16x16x32_bf16 v[20:23], v[188:191], v[176:179], v[20:23]
    ds_read_b64_tr_b16 v[146:147], v231 offset:1536
    ds_read_b64_tr_b16 v[148:149], v231 offset:2048
    v_mfma_f32_16x16x32_bf16 v[92:95], v[176:179], v[196:199], v[92:95]
    ds_read_b64_tr_b16 v[150:151], v231 offset:2560
    ds_read_b64_tr_b16 v[140:141], v231 offset:0
    v_mfma_f32_16x16x32_bf16 v[60:63], v[192:195], v[180:183], v[60:63]
    ds_read_b64_tr_b16 v[142:143], v231 offset:512
    ds_read_b64_tr_b16 v[204:205], v231 offset:13312
    v_mfma_f32_16x16x32_bf16 v[24:27], v[188:191], v[180:183], v[24:27]
    ds_read_b64_tr_b16 v[206:207], v231 offset:13824
    ds_read_b64_tr_b16 v[208:209], v231 offset:14336
    v_mfma_f32_16x16x32_bf16 v[96:99], v[180:183], v[196:199], v[96:99]
    ds_read_b64_tr_b16 v[210:211], v231 offset:14848
    ds_read_b64_tr_b16 v[200:201], v231 offset:12288
    v_mfma_f32_16x16x32_bf16 v[64:67], v[192:195], v[184:187], v[64:67]
    ds_read_b64_tr_b16 v[202:203], v231 offset:12800
    ds_read_b128 v[128:131], v226 offset:10240
    v_mfma_f32_16x16x32_bf16 v[28:31], v[188:191], v[184:187], v[28:31]
    ds_read_b128 v[176:179], v227 offset:10240
    s_waitcnt lgkmcnt(9)
    ds_read_b128 v[132:135], v226 offset:12288
    v_mfma_f32_16x16x32_bf16 v[100:103], v[184:187], v[196:199], v[100:103]
    ds_read_b128 v[180:183], v227 offset:12288
    ds_read_b128 v[136:139], v226 offset:14336
    v_mfma_f32_16x16x32_bf16 v[32:35], v[192:195], v[152:155], v[32:35]
    ds_read_b128 v[184:187], v227 offset:14336
    ds_read_b128 v[104:107], v233 offset:7168
    v_mfma_f32_16x16x32_bf16 v[68:71], v[152:155], v[196:199], v[68:71]
    s_waitcnt lgkmcnt(9)
    ds_read_b128 v[108:111], v226 offset:0
    ds_read_b128 v[112:115], v226 offset:2048
    v_mfma_f32_16x16x32_bf16 v[36:39], v[192:195], v[156:159], v[36:39]
    ds_read_b128 v[152:155], v234 offset:7168
    ds_read_b128 v[116:119], v226 offset:4096
    v_mfma_f32_16x16x32_bf16 v[0:3], v[188:191], v[156:159], v[0:3]
    ds_read_b128 v[120:123], v226 offset:6144
    s_waitcnt lgkmcnt(9)
    ds_read_b128 v[124:127], v226 offset:8192
    v_mfma_f32_16x16x32_bf16 v[72:75], v[156:159], v[196:199], v[72:75]
    ds_read_b32 v225, v224
    v_mfma_f32_16x16x32_bf16 v[40:43], v[192:195], v[160:163], v[40:43]
    ds_read_b128 v[156:159], v227 offset:0
    v_mfma_f32_16x16x32_bf16 v[56:59], v[144:147], v[128:131], v[56:59]
    v_mfma_f32_16x16x32_bf16 v[92:95], v[128:131], v[148:151], v[92:95]
    v_mfma_f32_16x16x32_bf16 v[56:59], v[204:207], v[176:179], v[56:59]
    v_mfma_f32_16x16x32_bf16 v[92:95], v[176:179], v[208:211], v[92:95]
    v_mfma_f32_16x16x32_bf16 v[60:63], v[144:147], v[132:135], v[60:63]
    v_mfma_f32_16x16x32_bf16 v[24:27], v[140:143], v[132:135], v[24:27]
    v_mfma_f32_16x16x32_bf16 v[96:99], v[132:135], v[148:151], v[96:99]
    s_waitcnt lgkmcnt(1)
    v_cmp_ne_u32 vcc, 0, v225
    v_mfma_f32_16x16x32_bf16 v[60:63], v[204:207], v[180:183], v[60:63]
    v_mfma_f32_16x16x32_bf16 v[24:27], v[200:203], v[180:183], v[24:27]
    v_cvt_pk_bf16_f32 v56, v56, v57
    v_mfma_f32_16x16x32_bf16 v[96:99], v[180:183], v[208:211], v[96:99]
    v_cvt_pk_bf16_f32 v57, v58, v59
    v_cvt_pk_bf16_f32 v242, v92, v93
    v_mfma_f32_16x16x32_bf16 v[64:67], v[144:147], v[136:139], v[64:67]
    v_cvt_pk_bf16_f32 v243, v94, v95
    s_nop 0
    v_cvt_pk_bf16_f32 v60, v60, v61
    v_mfma_f32_16x16x32_bf16 v[28:31], v[140:143], v[136:139], v[28:31]
    v_cvt_pk_bf16_f32 v61, v62, v63
    v_cndmask_b32 v62, v60, v56, s[58:59]
    v_mfma_f32_16x16x32_bf16 v[100:103], v[136:139], v[148:151], v[100:103]
    v_cvt_pk_bf16_f32 v240, v96, v97
    v_cvt_pk_bf16_f32 v241, v98, v99
    v_mfma_f32_16x16x32_bf16 v[64:67], v[204:207], v[184:187], v[64:67]
    v_cndmask_b32 v63, v61, v57, s[58:59]
    v_cvt_pk_bf16_f32 v24, v24, v25
    v_mfma_f32_16x16x32_bf16 v[28:31], v[200:203], v[184:187], v[28:31]
    v_cvt_pk_bf16_f32 v25, v26, v27
    v_cndmask_b32 v26, v24, 0, s[58:59]
    v_mfma_f32_16x16x32_bf16 v[100:103], v[184:187], v[208:211], v[100:103]
    v_cndmask_b32 v27, v25, 0, s[58:59]
    v_cndmask_b32 v24, 0, v24, s[58:59]
    v_mfma_f32_16x16x32_bf16 v[32:35], v[144:147], v[104:107], v[32:35]
    v_cvt_pk_bf16_f32 v64, v64, v65
    v_cvt_pk_bf16_f32 v65, v66, v67
    v_mfma_f32_16x16x32_bf16 v[68:71], v[104:107], v[148:151], v[68:71]
    v_cndmask_b32 v25, 0, v25, s[58:59]
    v_cndmask_b32 v66, v64, v60, s[58:59]
    v_mfma_f32_16x16x32_bf16 v[32:35], v[204:207], v[152:155], v[32:35]
    v_cvt_pk_bf16_f32 v238, v100, v101
    v_cvt_pk_bf16_f32 v239, v102, v103
    v_mfma_f32_16x16x32_bf16 v[132:135], v[60:63], v[24:27], v[212:215]
    v_cndmask_b32 v67, v65, v61, s[58:59]
    v_cvt_pk_bf16_f32 v28, v28, v29
    v_mfma_f32_16x16x32_bf16 v[68:71], v[152:155], v[208:211], v[68:71]
    v_cvt_pk_bf16_f32 v29, v30, v31
    v_cndmask_b32 v30, v28, 0, s[58:59]
    v_mfma_f32_16x16x32_bf16 v[36:39], v[144:147], v[108:111], v[36:39]
    v_cndmask_b32 v31, v29, 0, s[58:59]
    v_cndmask_b32 v28, 0, v28, s[58:59]
    v_mfma_f32_16x16x32_bf16 v[0:3], v[140:143], v[108:111], v[0:3]
    v_cndmask_b32 v29, 0, v29, s[58:59]
    v_max3_f32 v180, v132, v133, v134
    v_mfma_f32_16x16x32_bf16 v[72:75], v[108:111], v[148:151], v[72:75]
    v_max_f32 v180, v180, v135
    v_cvt_pk_bf16_f32 v32, v32, v33
    v_mfma_f32_16x16x32_bf16 v[136:139], v[64:67], v[28:31], v[212:215]
    v_cvt_pk_bf16_f32 v33, v34, v35
    v_cvt_pk_bf16_f32 v254, v68, v69
    s_waitcnt lgkmcnt(0)
    v_mfma_f32_16x16x32_bf16 v[36:39], v[204:207], v[156:159], v[36:39]
    v_cvt_pk_bf16_f32 v255, v70, v71
    v_mfma_f32_16x16x32_bf16 v[0:3], v[200:203], v[156:159], v[0:3]
    v_mfma_f32_16x16x32_bf16 v[72:75], v[156:159], v[208:211], v[72:75]
    v_mfma_f32_16x16x32_bf16 v[4:7], v[188:191], v[160:163], v[4:7]
    v_max3_f32 v184, v136, v137, v138
    v_mfma_f32_16x16x32_bf16 v[76:79], v[160:163], v[196:199], v[76:79]
    v_max_f32 v184, v184, v139
    s_nop 0
    v_cvt_pk_bf16_f32 v36, v36, v37
    v_mfma_f32_16x16x32_bf16 v[40:43], v[144:147], v[112:115], v[40:43]
    ds_read_b128 v[160:163], v227 offset:2048
    v_permlane32_swap_b32 v180, v184
    v_mfma_f32_16x16x32_bf16 v[4:7], v[140:143], v[112:115], v[4:7]
    v_max_f32 v181, v180, v184
    v_max_f32 v180, v180, v184
    v_mfma_f32_16x16x32_bf16 v[76:79], v[112:115], v[148:151], v[76:79]
    v_cvt_pk_bf16_f32 v37, v38, v39
    v_permlane16_swap_b32 v180, v181
    v_mfma_f32_16x16x32_bf16 v[44:47], v[192:195], v[164:167], v[44:47]
    v_max_f32 v180, v180, v181
    v_mul_f32 v184, s56, -v180
    v_mfma_f32_16x16x32_bf16 v[8:11], v[188:191], v[164:167], v[8:11]
    v_mul_f32 v180, s56, -v180
    v_cvt_pk_bf16_f32 v252, v72, v73
    v_mfma_f32_16x16x32_bf16 v[80:83], v[164:167], v[196:199], v[80:83]
    v_permlane32_swap_b32 v180, v184
    v_fma_f32 v132, v132, s56, v180
    v_mfma_f32_16x16x32_bf16 v[44:47], v[144:147], v[116:119], v[44:47]
    ds_read_b128 v[164:167], v227 offset:4096
    v_fma_f32 v133, v133, s56, v180
    v_mfma_f32_16x16x32_bf16 v[8:11], v[140:143], v[116:119], v[8:11]
    v_fma_f32 v134, v134, s56, v180
    v_fma_f32 v135, v135, s56, v180
    v_mfma_f32_16x16x32_bf16 v[80:83], v[116:119], v[148:151], v[80:83]
    v_exp_f32 v132, v132
    s_waitcnt lgkmcnt(1)
    v_mfma_f32_16x16x32_bf16 v[40:43], v[204:207], v[160:163], v[40:43]
    v_exp_f32 v133, v133
    v_mfma_f32_16x16x32_bf16 v[4:7], v[200:203], v[160:163], v[4:7]
    v_exp_f32 v134, v134
    v_mfma_f32_16x16x32_bf16 v[76:79], v[160:163], v[208:211], v[76:79]
    v_exp_f32 v135, v135
    v_mfma_f32_16x16x32_bf16 v[48:51], v[192:195], v[168:171], v[48:51]
    v_cvt_pk_bf16_f32 v24, v132, v133
    v_cvt_pk_bf16_f32 v25, v134, v135
    v_mfma_f32_16x16x32_bf16 v[12:15], v[188:191], v[168:171], v[12:15]
    v_cndmask_b32 v26, 0, v24, s[60:61]
    v_cndmask_b32 v27, 0, v25, s[60:61]
    v_mfma_f32_16x16x32_bf16 v[84:87], v[168:171], v[196:199], v[84:87]
    v_cndmask_b32 v24, v24, 0, s[60:61]
    v_cndmask_b32 v25, v25, 0, s[60:61]
    s_waitcnt lgkmcnt(0)
    v_mfma_f32_16x16x32_bf16 v[44:47], v[204:207], v[164:167], v[44:47]
    ds_read_b128 v[168:171], v227 offset:6144
    v_fma_f32 v136, v136, s56, v184
    v_mfma_f32_16x16x32_bf16 v[180:183], v[220:223], v[24:27], 0
    v_fma_f32 v137, v137, s56, v184
    v_fma_f32 v138, v138, s56, v184
    v_mfma_f32_16x16x32_bf16 v[96:99], v[240:243], v[24:27], 0
    v_fma_f32 v139, v139, s56, v184
    v_exp_f32 v136, v136
    v_mfma_f32_16x16x32_bf16 v[8:11], v[200:203], v[164:167], v[8:11]
    v_exp_f32 v137, v137
    v_mfma_f32_16x16x32_bf16 v[80:83], v[164:167], v[208:211], v[80:83]
    v_exp_f32 v138, v138
    v_mfma_f32_16x16x32_bf16 v[48:51], v[144:147], v[120:123], v[48:51]
    v_exp_f32 v139, v139
    v_mfma_f32_16x16x32_bf16 v[12:15], v[140:143], v[120:123], v[12:15]
    v_cvt_pk_bf16_f32 v28, v136, v137
    v_cvt_pk_bf16_f32 v29, v138, v139
    v_mfma_f32_16x16x32_bf16 v[84:87], v[120:123], v[148:151], v[84:87]
    v_cndmask_b32 v30, 0, v28, s[60:61]
    v_cndmask_b32 v31, 0, v29, s[60:61]
    v_mfma_f32_16x16x32_bf16 v[52:55], v[192:195], v[172:175], v[52:55]
    v_cndmask_b32 v28, v28, 0, s[60:61]
    v_cndmask_b32 v29, v29, 0, s[60:61]
    s_waitcnt lgkmcnt(0)
    v_mfma_f32_16x16x32_bf16 v[48:51], v[204:207], v[168:171], v[48:51]
    v_rcp_f32 v180, v180
    v_mfma_f32_16x16x32_bf16 v[184:187], v[220:223], v[28:31], 0
    v_mul_f32 v96, v96, v180
    v_mul_f32 v97, v97, v180
    v_mfma_f32_16x16x32_bf16 v[100:103], v[238:241], v[28:31], 0
    v_mul_f32 v98, v98, v180
    v_mul_f32 v99, v99, v180
    v_mfma_f32_16x16x32_bf16 v[12:15], v[200:203], v[168:171], v[12:15]
    v_cvt_pk_bf16_f32 v132, v96, v97
    v_cvt_pk_bf16_f32 v133, v98, v99
    v_mfma_f32_16x16x32_bf16 v[84:87], v[168:171], v[208:211], v[84:87]
    v_rcp_f32 v184, v184
    v_mfma_f32_16x16x32_bf16 v[16:19], v[188:191], v[172:175], v[16:19]
    v_mul_f32 v100, v100, v184
    v_mul_f32 v101, v101, v184
    v_mfma_f32_16x16x32_bf16 v[88:91], v[172:175], v[196:199], v[88:91]
    v_mul_f32 v102, v102, v184
    v_mul_f32 v103, v103, v184
    v_mfma_f32_16x16x32_bf16 v[52:55], v[144:147], v[124:127], v[52:55]
    ds_read_b128 v[172:175], v227 offset:8192
    v_cvt_pk_bf16_f32 v134, v100, v101
    v_mfma_f32_16x16x32_bf16 v[16:19], v[140:143], v[124:127], v[16:19]
    v_cvt_pk_bf16_f32 v135, v102, v103
    v_permlane16_swap_b32 v132, v134
    v_mfma_f32_16x16x32_bf16 v[88:91], v[124:127], v[148:151], v[88:91]
    v_permlane16_swap_b32 v133, v135
    buffer_store_dwordx4 v[132:135], v235, s[40:43], s15 offen sc1
    v_mfma_f32_16x16x32_bf16 v[20:23], v[140:143], v[128:131], v[20:23]
    v_cvt_pk_bf16_f32 v253, v74, v75
    v_cvt_pk_bf16_f32 v40, v40, v41
    v_mfma_f32_16x16x32_bf16 v[20:23], v[200:203], v[176:179], v[20:23]
    v_cvt_pk_bf16_f32 v41, v42, v43
    v_cvt_pk_bf16_f32 v250, v76, v77
    v_cvt_pk_bf16_f32 v251, v78, v79
    v_cndmask_b32 v38, v36, v32, s[58:59]
    v_cndmask_b32 v39, v37, v33, s[58:59]
    v_cvt_pk_bf16_f32 v0, v0, v1
    v_cvt_pk_bf16_f32 v1, v2, v3
    v_cndmask_b32 v2, v0, 0, s[58:59]
    v_cndmask_b32 v3, v1, 0, s[58:59]
    v_cndmask_b32 v0, 0, v0, s[58:59]
    v_cndmask_b32 v1, 0, v1, s[58:59]
    v_cndmask_b32 v42, v40, v36, s[58:59]
    v_cndmask_b32 v43, v41, v37, s[58:59]
    v_mfma_f32_16x16x32_bf16 v[108:111], v[36:39], v[0:3], v[216:219]
    v_cvt_pk_bf16_f32 v4, v4, v5
    v_cvt_pk_bf16_f32 v5, v6, v7
    s_waitcnt lgkmcnt(0)
    v_mfma_f32_16x16x32_bf16 v[52:55], v[204:207], v[172:175], v[52:55]
    v_cndmask_b32 v6, v4, 0, s[58:59]
    v_cndmask_b32 v7, v5, 0, s[58:59]
    v_mfma_f32_16x16x32_bf16 v[16:19], v[200:203], v[172:175], v[16:19]
    v_cndmask_b32 v4, 0, v4, s[58:59]
    v_cndmask_b32 v5, 0, v5, s[58:59]
    v_mfma_f32_16x16x32_bf16 v[88:91], v[172:175], v[208:211], v[88:91]
    v_max3_f32 v156, v108, v109, v110
    v_max_f32 v156, v156, v111
    v_mfma_f32_16x16x32_bf16 v[112:115], v[40:43], v[4:7], v[212:215]
    v_cvt_pk_bf16_f32 v44, v44, v45
    v_cvt_pk_bf16_f32 v45, v46, v47
    v_cvt_pk_bf16_f32 v248, v80, v81
    v_cvt_pk_bf16_f32 v249, v82, v83
    v_cvt_pk_bf16_f32 v48, v48, v49
    v_cvt_pk_bf16_f32 v49, v50, v51
    v_cvt_pk_bf16_f32 v246, v84, v85
    v_cvt_pk_bf16_f32 v247, v86, v87
    v_max3_f32 v160, v112, v113, v114
    v_max_f32 v160, v160, v115
    v_cndmask_b32 v46, v44, v40, s[58:59]
    v_cndmask_b32 v47, v45, v41, s[58:59]
    v_permlane32_swap_b32 v156, v160
    v_max_f32 v157, v156, v160
    v_max_f32 v156, v156, v160
    v_cvt_pk_bf16_f32 v8, v8, v9
    v_cvt_pk_bf16_f32 v9, v10, v11
    v_permlane16_swap_b32 v156, v157
    v_max_f32 v156, v156, v157
    v_mul_f32 v160, s56, -v156
    v_mul_f32 v156, s56, -v156
    v_cndmask_b32 v10, v8, 0, s[58:59]
    v_cndmask_b32 v11, v9, 0, s[58:59]
    v_permlane32_swap_b32 v156, v160
    v_fma_f32 v108, v108, s56, v156
    v_fma_f32 v109, v109, s56, v156
    v_fma_f32 v110, v110, s56, v156
    v_fma_f32 v111, v111, s56, v156
    v_exp_f32 v108, v108
    v_exp_f32 v109, v109
    v_exp_f32 v110, v110
    v_exp_f32 v111, v111
    v_cvt_pk_bf16_f32 v0, v108, v109
    v_cvt_pk_bf16_f32 v1, v110, v111
    v_cndmask_b32 v2, 0, v0, s[60:61]
    v_cndmask_b32 v3, 0, v1, s[60:61]
    v_cndmask_b32 v0, v0, 0, s[60:61]
    v_cndmask_b32 v1, v1, 0, s[60:61]
    v_fma_f32 v112, v112, s56, v160
    v_fma_f32 v113, v113, s56, v160
    v_mfma_f32_16x16x32_bf16 v[156:159], v[220:223], v[0:3], 0
    v_fma_f32 v114, v114, s56, v160
    v_fma_f32 v115, v115, s56, v160
    v_mfma_f32_16x16x32_bf16 v[72:75], v[252:255], v[0:3], 0
    v_exp_f32 v112, v112
    v_exp_f32 v113, v113
    v_exp_f32 v114, v114
    v_exp_f32 v115, v115
    v_cvt_pk_bf16_f32 v4, v112, v113
    v_cvt_pk_bf16_f32 v5, v114, v115
    v_cndmask_b32 v6, 0, v4, s[60:61]
    v_cndmask_b32 v7, 0, v5, s[60:61]
    v_cndmask_b32 v4, v4, 0, s[60:61]
    v_cndmask_b32 v5, v5, 0, s[60:61]
    v_rcp_f32 v156, v156
    v_cndmask_b32 v8, 0, v8, s[58:59]
    v_mfma_f32_16x16x32_bf16 v[160:163], v[220:223], v[4:7], 0
    v_mul_f32 v72, v72, v156
    v_mul_f32 v73, v73, v156
    v_mfma_f32_16x16x32_bf16 v[76:79], v[250:253], v[4:7], 0
    v_mul_f32 v74, v74, v156
    v_mul_f32 v75, v75, v156
    v_cvt_pk_bf16_f32 v108, v72, v73
    v_cvt_pk_bf16_f32 v109, v74, v75
    v_cndmask_b32 v9, 0, v9, s[58:59]
    v_rcp_f32 v160, v160
    v_cndmask_b32 v50, v48, v44, s[58:59]
    v_mfma_f32_16x16x32_bf16 v[116:119], v[44:47], v[8:11], v[212:215]
    v_mul_f32 v76, v76, v160
    v_mul_f32 v77, v77, v160
    v_mul_f32 v78, v78, v160
    v_mul_f32 v79, v79, v160
    v_cvt_pk_bf16_f32 v110, v76, v77
    v_cvt_pk_bf16_f32 v111, v78, v79
    v_cndmask_b32 v51, v49, v45, s[58:59]
    v_permlane16_swap_b32 v108, v110
    v_permlane16_swap_b32 v109, v111
    buffer_store_dwordx4 v[108:111], v235, s[40:43], s12 offen sc1
    v_cvt_pk_bf16_f32 v12, v12, v13
    v_cvt_pk_bf16_f32 v13, v14, v15
    v_cndmask_b32 v14, v12, 0, s[58:59]
    v_cndmask_b32 v15, v13, 0, s[58:59]
    v_cndmask_b32 v12, 0, v12, s[58:59]
    v_cndmask_b32 v13, 0, v13, s[58:59]
    v_max3_f32 v164, v116, v117, v118
    v_max_f32 v164, v164, v119
    v_mfma_f32_16x16x32_bf16 v[120:123], v[48:51], v[12:15], v[212:215]
    v_cvt_pk_bf16_f32 v52, v52, v53
    v_cvt_pk_bf16_f32 v53, v54, v55
    v_cvt_pk_bf16_f32 v244, v88, v89
    v_cvt_pk_bf16_f32 v245, v90, v91
    v_cndmask_b32 v54, v52, v48, s[58:59]
    v_cndmask_b32 v55, v53, v49, s[58:59]
    v_cvt_pk_bf16_f32 v16, v16, v17
    v_cvt_pk_bf16_f32 v17, v18, v19
    v_max3_f32 v168, v120, v121, v122
    s_waitcnt vmcnt(1)
    s_cbranch_vccz L_fs30
    buffer_store_dword v237, v236, s[40:43], s45 offen offset:384
L_fb30:
    v_max_f32 v168, v168, v123
    v_cndmask_b32 v18, v16, 0, s[58:59]
    v_cndmask_b32 v19, v17, 0, s[58:59]
    v_permlane32_swap_b32 v164, v168
    v_max_f32 v165, v164, v168
    v_max_f32 v164, v164, v168
    v_cndmask_b32 v16, 0, v16, s[58:59]
    v_cndmask_b32 v17, 0, v17, s[58:59]
    v_permlane16_swap_b32 v164, v165
    v_max_f32 v164, v164, v165
    v_mfma_f32_16x16x32_bf16 v[124:127], v[52:55], v[16:19], v[212:215]
    v_mul_f32 v168, s56, -v164
    v_mul_f32 v164, s56, -v164
    v_cndmask_b32 v58, v56, v52, s[58:59]
    v_cndmask_b32 v59, v57, v53, s[58:59]
    v_permlane32_swap_b32 v164, v168
    v_fma_f32 v116, v116, s56, v164
    v_fma_f32 v117, v117, s56, v164
    v_fma_f32 v118, v118, s56, v164
    v_fma_f32 v119, v119, s56, v164
    v_exp_f32 v116, v116
    v_exp_f32 v117, v117
    v_exp_f32 v118, v118
    v_exp_f32 v119, v119
    v_cvt_pk_bf16_f32 v8, v116, v117
    v_cvt_pk_bf16_f32 v9, v118, v119
    v_cndmask_b32 v10, 0, v8, s[60:61]
    v_cndmask_b32 v11, 0, v9, s[60:61]
    v_cndmask_b32 v8, v8, 0, s[60:61]
    v_cndmask_b32 v9, v9, 0, s[60:61]
    v_fma_f32 v120, v120, s56, v168
    v_fma_f32 v121, v121, s56, v168
    v_mfma_f32_16x16x32_bf16 v[164:167], v[220:223], v[8:11], 0
    v_fma_f32 v122, v122, s56, v168
    v_fma_f32 v123, v123, s56, v168
    v_mfma_f32_16x16x32_bf16 v[80:83], v[248:251], v[8:11], 0
    v_exp_f32 v120, v120
    v_exp_f32 v121, v121
    v_exp_f32 v122, v122
    v_exp_f32 v123, v123
    v_cvt_pk_bf16_f32 v12, v120, v121
    v_cvt_pk_bf16_f32 v13, v122, v123
    v_cndmask_b32 v14, 0, v12, s[60:61]
    v_cndmask_b32 v15, 0, v13, s[60:61]
    v_cndmask_b32 v12, v12, 0, s[60:61]
    v_cndmask_b32 v13, v13, 0, s[60:61]
    v_rcp_f32 v164, v164
    v_cvt_pk_bf16_f32 v20, v20, v21
    v_mfma_f32_16x16x32_bf16 v[168:171], v[220:223], v[12:15], 0
    v_mul_f32 v80, v80, v164
    v_mul_f32 v81, v81, v164
    v_mfma_f32_16x16x32_bf16 v[84:87], v[246:249], v[12:15], 0
    v_mul_f32 v82, v82, v164
    v_mul_f32 v83, v83, v164
    v_cvt_pk_bf16_f32 v116, v80, v81
    v_cvt_pk_bf16_f32 v117, v82, v83
    v_cvt_pk_bf16_f32 v21, v22, v23
    v_rcp_f32 v168, v168
    v_cndmask_b32 v22, v20, 0, s[58:59]
    v_cndmask_b32 v23, v21, 0, s[58:59]
    v_mul_f32 v84, v84, v168
    v_mul_f32 v85, v85, v168
    v_mul_f32 v86, v86, v168
    v_mul_f32 v87, v87, v168
    v_cvt_pk_bf16_f32 v118, v84, v85
    v_cvt_pk_bf16_f32 v119, v86, v87
    v_cndmask_b32 v20, 0, v20, s[58:59]
    v_permlane16_swap_b32 v116, v118
    v_permlane16_swap_b32 v117, v119
    buffer_store_dwordx4 v[116:119], v235, s[40:43], s13 offen sc1
    v_cndmask_b32 v21, 0, v21, s[58:59]
    v_max3_f32 v172, v124, v125, v126
    v_max_f32 v172, v172, v127
    v_mfma_f32_16x16x32_bf16 v[128:131], v[56:59], v[20:23], v[212:215]
    s_nop 7
    v_max3_f32 v176, v128, v129, v130
    v_max_f32 v176, v176, v131
    s_nop 1
    v_permlane32_swap_b32 v172, v176
    v_max_f32 v173, v172, v176
    v_max_f32 v172, v172, v176
    s_nop 1
    v_permlane16_swap_b32 v172, v173
    v_max_f32 v172, v172, v173
    v_mul_f32 v176, s56, -v172
    v_mul_f32 v172, s56, -v172
    s_nop 1
    v_permlane32_swap_b32 v172, v176
    v_fma_f32 v124, v124, s56, v172
    v_fma_f32 v125, v125, s56, v172
    v_fma_f32 v126, v126, s56, v172
    v_fma_f32 v127, v127, s56, v172
    v_exp_f32 v124, v124
    v_exp_f32 v125, v125
    v_exp_f32 v126, v126
    v_exp_f32 v127, v127
    v_cvt_pk_bf16_f32 v16, v124, v125
    v_cvt_pk_bf16_f32 v17, v126, v127
    s_waitcnt vmcnt(2)
    s_cbranch_vccz L_fs31
    buffer_store_dword v237, v236, s[40:43], s45 offen offset:32
L_fb31:
    v_cndmask_b32 v18, 0, v16, s[60:61]
    v_cndmask_b32 v19, 0, v17, s[60:61]
    v_cndmask_b32 v16, v16, 0, s[60:61]
    v_cndmask_b32 v17, v17, 0, s[60:61]
    v_fma_f32 v128, v128, s56, v176
    v_fma_f32 v129, v129, s56, v176
    v_mfma_f32_16x16x32_bf16 v[172:175], v[220:223], v[16:19], 0
    v_fma_f32 v130, v130, s56, v176
    v_fma_f32 v131, v131, s56, v176
    v_mfma_f32_16x16x32_bf16 v[88:91], v[244:247], v[16:19], 0
    v_exp_f32 v128, v128
    v_exp_f32 v129, v129
    v_exp_f32 v130, v130
    v_exp_f32 v131, v131
    v_cvt_pk_bf16_f32 v20, v128, v129
    v_cvt_pk_bf16_f32 v21, v130, v131
    v_cndmask_b32 v22, 0, v20, s[60:61]
    v_cndmask_b32 v23, 0, v21, s[60:61]
    v_cndmask_b32 v20, v20, 0, s[60:61]
    v_cndmask_b32 v21, v21, 0, s[60:61]
    v_rcp_f32 v172, v172
    s_nop 0
    v_mfma_f32_16x16x32_bf16 v[176:179], v[220:223], v[20:23], 0
    v_mul_f32 v88, v88, v172
    v_mul_f32 v89, v89, v172
    v_mfma_f32_16x16x32_bf16 v[92:95], v[242:245], v[20:23], 0
    v_mul_f32 v90, v90, v172
    v_mul_f32 v91, v91, v172
    v_cvt_pk_bf16_f32 v124, v88, v89
    v_cvt_pk_bf16_f32 v125, v90, v91
    s_nop 0
    v_rcp_f32 v176, v176
    s_nop 1
    v_mul_f32 v92, v92, v176
    v_mul_f32 v93, v93, v176
    v_mul_f32 v94, v94, v176
    v_mul_f32 v95, v95, v176
    v_cvt_pk_bf16_f32 v126, v92, v93
    v_cvt_pk_bf16_f32 v127, v94, v95
    s_nop 0
    v_permlane16_swap_b32 v124, v126
    v_permlane16_swap_b32 v125, v127
    buffer_store_dwordx4 v[124:127], v235, s[40:43], s14 offen sc1
    s_waitcnt vmcnt(2)
    s_cbranch_vccz L_fs32
    buffer_store_dword v237, v236, s[40:43], s45 offen offset:192
L_fb32:
    s_waitcnt vmcnt(1)
    s_cbranch_vccz L_fs33
    buffer_store_dword v237, v236, s[40:43], s45 offen offset:352
L_fb33:
    s_endpgm
L_fs30:
    buffer_store_dword v237, v236, s[40:43], s45 offen offset:384 sc1
    s_branch L_fb30
L_fs31:
    buffer_store_dword v237, v236, s[40:43], s45 offen offset:32 sc1
    s_branch L_fb31
L_fs32:
    buffer_store_dword v237, v236, s[40:43], s45 offen offset:192 sc1
    s_branch L_fb32
L_fs33:
    buffer_store_dword v237, v236, s[40:43], s45 offen offset:352 sc1
    s_branch L_fb33
L_ve3:
.fill (3520-(L_ve3-L_w3))/4, 4, 0xbf800000
    .p2align 12
.fill 64, 4, 0xbf800000
.section .rodata,"a"
.p2align 6
.amdhsa_kernel concat_heads__sliding_local_dilated__sliding_local_dilated__prompt_kernel
  .amdhsa_next_free_vgpr 256
  .amdhsa_next_free_sgpr 102
  .amdhsa_accum_offset 256
  .amdhsa_group_segment_fixed_size 0
  .amdhsa_kernarg_size 72
  .amdhsa_user_sgpr_count 2
  .amdhsa_user_sgpr_kernarg_segment_ptr 1
  .amdhsa_system_sgpr_workgroup_id_x 1
  .amdhsa_float_denorm_mode_32 3
.end_amdhsa_kernel
.text
```
